```python
import torch

def _softmax(x, axis=-1):
    return torch.softmax(x, dim=axis)
def _gelu(x):
    return torch.nn.functional.gelu(x, approximate="tanh")
def _silu(x):
    return torch.nn.functional.silu(x)
def _sigmoid(x):
    return torch.sigmoid(x)
def _layernorm(x, axis=-1, eps=1e-5):
    m = x.mean(dim=axis, keepdim=True)
    v = x.var(dim=axis, keepdim=True, unbiased=False)
    return (x - m) / torch.sqrt(v + eps)
def _scatter_add(tgt, idx, src, axis=0):
    return tgt.clone().index_add_(axis, idx, src)
def _segment_sum(src, seg, n):
    out = torch.zeros((n,) + src.shape[1:], dtype=src.dtype)
    return out.index_add_(0, seg, src)
def _pad(x, pw):
    flat = tuple(v for pair in reversed(pw) for v in pair)
    return torch.nn.functional.pad(x, flat)

kernel_name = 'interleave_layers__sliding_block_cached__dense_activation_silu__decode'

def setup_inputs():

    _w = (lambda a: (lambda t: t.to(torch.bfloat16) if t.is_floating_point() else t)(torch.as_tensor(a)))
    def _A_setup():
        B, Sq, D = 4, 1, 512
        Hq, Hkv, Sk, Dh = 32, 8, 4096, 128
        assert Hq % Hkv == 0, (Hq, Hkv)
        return {
            "x": _w((lambda *s: torch.randn(*s, dtype=torch.bfloat16) * 0.1)(B, Sq, D)),
            "k_cache": _w((lambda *s: torch.randn(*s, dtype=torch.bfloat16) * 0.8)(B, Hkv, Sk, Dh)),
            "v_cache": _w((lambda *s: torch.randn(*s, dtype=torch.bfloat16) * 3.2)(B, Hkv, Sk, Dh)),
            "wq": _w((lambda *s: torch.randn(*s, dtype=torch.bfloat16) * 0.8)(D, Hq * Dh) * (D ** -0.5)),
            "wo": _w((lambda *s: torch.randn(*s, dtype=torch.bfloat16) * 3.2)(Hq * Dh, D) * ((Hq * Dh) ** -0.5)),
        }
    _A_in = _A_setup()

    def _B_setup():
        B, S, D, F = 4, 1, 512, 1792
        return {
            "x": _w((lambda *s: torch.randn(*s, dtype=torch.bfloat16) * 0.1)(B, S, D)),
            "w1": _w((lambda *s: torch.randn(*s, dtype=torch.bfloat16) * 1.6)(D, F) * (D ** -0.5)),
            "w2": _w((lambda *s: torch.randn(*s, dtype=torch.bfloat16) * 0.4)(F, D) * (F ** -0.5)),
        }
    _B_in = _B_setup()

    return {
        "A_x": _A_in["x"],
        "A_k_cache": _A_in["k_cache"],
        "A_v_cache": _A_in["v_cache"],
        "A_wq": _A_in["wq"],
        "A_wo": _A_in["wo"],
        "B_x": _B_in["x"],
        "B_w1": _B_in["w1"],
        "B_w2": _B_in["w2"],
    }

def reference(A_x, A_k_cache, A_v_cache, A_wq, A_wo, B_x, B_w1, B_w2):
    def _A_ref(x, k_cache, v_cache, wq, wo):
        B, Sq, D = x.shape
        Hq, Dh = 32, 128
        Hkv, Sk = k_cache.shape[1], k_cache.shape[2]
        W = min(4096, max(256, Sk // 4))
        rep = Hq // Hkv
        q = (lambda x, *d: x.permute(*d))((x @ wq).reshape(B, Sq, Hq, Dh), 0, 2, 1, 3)
        k = (lambda x, n, axis: torch.repeat_interleave(x, n, dim=axis))(k_cache[:, :, Sk - W:, :], rep, axis=1)
        v = (lambda x, n, axis: torch.repeat_interleave(x, n, dim=axis))(v_cache[:, :, Sk - W:, :], rep, axis=1)
        scores = torch.einsum("bhqd,bhkd->bhqk", q, k) * (Dh ** -0.5)
        p = _softmax(scores, axis=-1)
        o = torch.einsum("bhqk,bhkd->bhqd", p, v)
        return (lambda x, *d: x.permute(*d))(o, 0, 2, 1, 3).reshape(B, Sq, Hq * Dh) @ wo

    def _B_ref(x, w1, w2):
        h = torch.einsum("bsd,df->bsf", x, w1)
        h = _silu(h)
        out = torch.einsum("bsf,fd->bsd", h, w2)
        return out

    x = A_x
    x = x + _A_ref(_layernorm(x, axis=-1), A_k_cache, A_v_cache, A_wq, A_wo)
    x = x + _B_ref(_layernorm(x, axis=-1), B_w1, B_w2)
    x = x + _A_ref(_layernorm(x, axis=-1), A_k_cache, A_v_cache, A_wq, A_wo)
    x = x + _B_ref(_layernorm(x, axis=-1), B_w1, B_w2)
    return x
```

```asm
; @launch grid=(256,1,1) block=(512,1,1) lds=160256
.amdgcn_target "amdgcn-amd-amdhsa--gfx950"
.text
.globl interleave_layers__sliding_block_cached__dense_activation_silu__decode_kernel
.p2align 8
.type interleave_layers__sliding_block_cached__dense_activation_silu__decode_kernel,@function
interleave_layers__sliding_block_cached__dense_activation_silu__decode_kernel:
    s_cmp_ge_u32 s2, 256
    s_cbranch_scc1 L_end
    s_load_dwordx16 s[4:19], s[0:1], 0
    s_load_dwordx4 s[20:23], s[0:1], 64
    s_load_dwordx2 s[24:25], s[0:1], 80
    s_getpc_b64 s[44:45]
    s_lshr_b32 s48, s2, 3
    s_lshl_b32 s48, s48, 10
    v_lshlrev_b32 v214, 7, v0
    v_add_u32 v214, s48, v214
    v_cmp_gt_u32 vcc, 8, v0
    s_and_saveexec_b64 s[42:43], vcc
    s_cbranch_execz L_noct
    global_load_dword v215, v214, s[44:45]
L_noct:
    s_mov_b64 exec, -1
    v_lshrrev_b32 v152, 6, v0
    v_and_b32 v1, 63, v0
    s_and_b32 s26, s2, 7
    v_readfirstlane_b32 s30, v152
    s_lshr_b32 s27, s2, 3
    s_lshr_b32 s28, s27, 3
    s_and_b32 s29, s27, 7
    v_lshrrev_b32 v4, 4, v1
    s_and_b32 s51, s30, 3
    s_xor_b32 s30, s30, 4
    s_cmp_lt_u32 s30, 4
    s_cbranch_scc1 L_role0
    v_lshrrev_b32 v153, 3, v1
    v_and_b32 v154, 7, v1
    v_lshlrev_b32 v155, 1, v4
    v_xor_b32 v154, v154, v155
    v_lshlrev_b32 v154, 4, v154
    s_lshl_b32 s48, s28, 20
    s_lshl_b32 s49, s51, 16
    s_add_u32 s48, s48, s49
    s_lshl_b32 s49, s26, 10
    s_add_u32 s48, s48, s49
    s_lshl_b32 s49, s29, 7
    s_add_u32 s48, s48, s49
    v_lshl_add_u32 v156, v153, 13, v154
    v_add_u32 v156, s48, v156
    s_lshl_b32 s53, s51, 10
    s_mov_b32 m0, s53
    s_waitcnt lgkmcnt(0)
    global_load_lds_dwordx4 v156, s[10:11] nt
    s_add_u32 m0, s53, 4096
    v_add_u32 v156, 0x40000, v156
    global_load_lds_dwordx4 v156, s[10:11] nt
    s_add_u32 m0, s53, 8192
    v_add_u32 v156, 0x40000, v156
    global_load_lds_dwordx4 v156, s[10:11] nt
    s_add_u32 m0, s53, 12288
    v_add_u32 v156, 0x40000, v156
    global_load_lds_dwordx4 v156, s[10:11] nt
    s_branch L_role1
L_role0:
    s_setprio 2
    v_and_b32 v2, 3, v1
    v_bfe_u32 v3, v1, 2, 2
    s_lshr_b32 s61, s30, 1
    s_and_b32 s63, s30, 1
    s_lshl_b32 s48, s28, 8
    s_lshl_b32 s49, s61, 10
    s_add_u32 s48, s48, s49
    s_lshl_b32 s49, s63, 7
    s_add_u32 s48, s48, s49
    v_and_b32 v59, 7, v1
    v_lshlrev_b32 v59, 4, v59
    v_lshl_add_u32 v59, v4, 2, v59
    v_add_u32 v59, s48, v59
    v_and_b32 v5, 15, v1
    s_lshl_b32 s52, s30, 11
    s_lshl_b32 s56, s26, 5
    s_add_u32 s57, s56, s27
    v_mov_b32 v7, 0
    v_lshlrev_b32 v164, 2, v5
    v_add_u32 v164, 158848, v164
    ds_write_b32 v164, v7
    s_waitcnt lgkmcnt(0)
    global_load_dword v166, v59, s[4:5]
    global_load_dword v167, v59, s[4:5] offset:2048
    v_mov_b32 v160, -1
    v_mov_b32 v161, -1
    v_mov_b32 v162, -1
    v_mov_b32 v163, -1
    v_lshlrev_b32 v165, 4, v1
    v_mov_b32 v157, 0
    s_cmp_lt_u32 s30, 2
    s_cbranch_scc1 Lc_1
    s_lshl_b32 s48, s57, 10
    s_and_b32 s49, s30, 1
    s_lshl_b32 s49, s49, 18
    s_add_u32 s48, s48, s49
    s_add_u32 s48, s48, 1572864
    v_add_u32 v30, s48, v165
    global_store_dwordx4 v30, v[160:163], s[24:25] sc1
    s_and_b32 s48, s27, 15
    s_cbranch_scc1 Lc_3
    s_and_b32 s49, s30, 1
    s_mul_i32 s49, s49, 294912
    s_lshl_b32 s48, s26, 8
    s_add_u32 s48, s48, s49
    s_lshl_b32 s49, s27, 3
    s_add_u32 s48, s48, s49
    s_add_u32 s48, s48, 262144
    v_lshrrev_b32 v164, 3, v1
    v_and_b32 v165, 0x70, v165
    v_lshl_add_u32 v164, v164, 11, v165
    v_add_u32 v164, s48, v164
    global_store_dwordx4 v164, v[160:163], s[24:25] sc1
    v_add_u32 v164, 147456, v164
    global_store_dwordx4 v164, v[160:163], s[24:25] sc1
    s_branch Lc_3
Lc_1:
    v_bfe_u32 v164, v1, 3, 1
    v_lshlrev_b32 v164, 13, v164
    v_and_b32 v159, 0x70, v165
    v_add_u32 v164, v164, v159
    s_cmp_eq_u32 s30, 1
    s_cbranch_scc1 Lc_2
    s_lshl_b32 s48, s28, 14
    s_lshl_b32 s49, s29, 10
    s_add_u32 s48, s48, s49
    s_lshl_b32 s49, s26, 7
    s_add_u32 s48, s48, s49
    s_add_u32 s48, s48, 131072
    s_mov_b32 s49, 147456
    v_mad_u32_u24 v158, v4, s49, v164
    v_add_u32 v158, s48, v158
    global_store_dwordx4 v158, v[160:163], s[24:25] sc1
    s_branch Lc_4
Lc_2:
    s_lshr_b32 s48, s2, 6
    s_lshl_b32 s48, s48, 14
    s_and_b32 s49, s2, 63
    s_lshl_b32 s49, s49, 7
    s_add_u32 s48, s48, s49
    s_add_u32 s48, s48, 65536
    v_add_u32 v164, s48, v164
    s_mov_b64 exec, 0xffff
    global_store_dwordx4 v164, v[160:163], s[24:25] sc1
    s_mov_b64 exec, -1
    s_lshl_b32 s48, s26, 10
    s_and_b32 s49, s27, 1
    s_lshl_b32 s49, s49, 13
    s_add_u32 s48, s48, s49
    s_add_u32 s48, s48, 8192
    v_add_u32 v30, s48, v165
    s_cmp_gt_u32 s27, 1
    s_cbranch_scc1 Lc_3
    global_store_dwordx4 v30, v[160:163], s[24:25] sc1
    s_branch Lc_3
Lc_4:
    s_lshl_b32 s48, s26, 16
    s_mul_i32 s49, s27, 1408
    s_add_u32 s48, s48, s49
    s_add_u32 s48, s48, 1048576
    v_lshlrev_b32 v164, 7, v5
    v_add_u32 v30, s48, v164
    s_lshl_b32 s48, s26, 11
    s_add_u32 s48, s48, 32768
    v_add_u32 v164, s48, v164
    v_cmp_gt_u32 vcc, 16, v1
    s_cmp_eq_u32 s27, 0
    s_cselect_b32 s42, 0xffff0000, 0
    s_or_b32 s42, s42, 0x7ff
    s_mov_b32 s43, 0
    v_cndmask_b32 v30, v164, v30, vcc
    s_mov_b64 exec, s[42:43]
    global_load_dword v215, v30, s[24:25]
    s_mov_b64 exec, -1
    v_mov_b32 v157, v30
    s_mov_b64 s[90:91], s[42:43]
    s_lshl_b32 s48, s26, 15
    s_mul_i32 s49, s27, 768
    s_add_u32 s48, s48, s49
    s_add_u32 s48, s48, 786432
    v_add_u32 v30, s48, v165
Lc_3:
    s_load_dword s31, s[24:25], 0
    s_barrier
    s_getreg_b32 s47, hwreg(HW_REG_XCC_ID, 0, 4)
    s_mov_b32 s36, 0xffffff00
    s_mov_b32 s37, 0
    s_mov_b64 s[38:39], s[24:25]
    s_add_u32 s40, s24, 2097152
    s_addc_u32 s41, s25, 0
    s_movk_i32 s62, 320
    s_mul_i32 s48, s61, 320
    s_lshl_b32 s49, s63, 7
    s_add_u32 s48, s48, s49
    s_add_u32 s48, s48, 151552
    v_bfe_u32 v192, v1, 2, 1
    v_lshlrev_b32 v23, 6, v192
    v_and_b32 v192, 1, v1
    v_lshl_add_u32 v23, v192, 5, v23
    v_lshrrev_b32 v192, 5, v1
    v_lshl_add_u32 v23, v192, 4, v23
    v_bfe_u32 v192, v1, 1, 1
    v_lshl_add_u32 v23, v192, 3, v23
    v_bfe_u32 v192, v1, 4, 1
    v_lshl_add_u32 v23, v192, 2, v23
    v_add_u32 v23, s48, v23
    v_lshlrev_b32 v193, 4, v4
    v_mad_u32_u24 v197, v3, s62, v193
    v_add_u32 v24, 151552, v197
    v_mov_b32 v194, 152832
    v_cmp_ne_u32 vcc, 0, v2
    s_lshl_b32 s66, s26, 16
    s_add_u32 s66, s66, 1048576
    v_cndmask_b32 v24, v24, v194, vcc
    s_lshl_b32 s67, s26, 15
    s_add_u32 s67, s67, 786432
    v_lshlrev_b32 v196, 2, v5
    s_lshl_b32 s48, s29, 6
    s_lshl_b32 s49, s28, 4
    s_add_u32 s48, s48, s49
    s_add_u32 s49, s48, s66
    s_add_u32 s49, s49, 0xA000
    v_lshlrev_b32 v194, 9, v4
    v_add_u32 v45, s49, v194
    s_mov_b32 s14, 0x00100001
    s_mov_b32 s15, 0x10000100
    s_lshl_b32 s58, s51, 6
    s_and_b32 s60, s27, 15
    s_add_u32 s92, s29, 1
    s_lshr_b32 s92, s92, 3
    v_add_u32 v32, 153152, v197
    s_add_u32 s49, s48, s67
    s_add_u32 s49, s49, 0x5000
    v_add_u32 v36, s49, v194
    v_mov_b32 v194, 0x3f803f80
    v_lshlrev_b32 v195, 2, v1
    v_add_u32 v195, 152832, v195
    ds_write_b32 v195, v194
    s_lshl_b32 s48, s29, 2
    s_add_u32 s48, s48, s28
    s_lshl_b32 s49, s48, 8
    s_add_u32 s49, s49, s58
    s_add_u32 s49, s49, s66
    v_lshl_add_u32 v35, v4, 13, v196
    v_add_u32 v35, s49, v35
    v_lshlrev_b32 v199, 4, v1
    s_lshl_b32 s48, s30, 10
    s_add_u32 s48, s48, s66
    s_add_u32 s49, s48, 0x8000
    v_add_u32 v15, s49, v199
    s_lshl_b32 s49, s28, 13
    s_add_u32 s49, s49, s48
    v_add_u32 v14, s49, v199
    s_lshl_b32 s59, s28, 6
    s_lshl_b32 s48, s28, 9
    s_lshl_b32 s49, s30, 6
    s_add_u32 s48, s48, s49
    s_add_u32 s49, s48, s66
    s_add_u32 s49, s49, 0xA000
    v_add_u32 v16, s49, v196
    s_add_u32 s49, s48, s67
    s_add_u32 s49, s49, 0x5000
    v_add_u32 v20, s49, v196
    v_lshlrev_b32 v195, 2, v1
    s_lshl_b32 s48, s30, 9
    s_add_u32 s48, s48, s67
    s_add_u32 s49, s48, 0x4000
    v_add_u32 v19, s49, v195
    s_lshl_b32 s49, s28, 12
    s_add_u32 s49, s49, s48
    v_add_u32 v17, s49, v195
    v_and_b32 v197, 1, v4
    v_lshrrev_b32 v194, 5, v1
    v_and_b32 v195, 31, v1
    v_lshlrev_b32 v195, 2, v195
    s_add_u32 s68, s24, 131072
    s_addc_u32 s69, s25, 0
    s_add_u32 s70, s24, 278528
    s_addc_u32 s71, s25, 0
    s_add_u32 s72, s24, 425984
    s_addc_u32 s73, s25, 0
    s_add_u32 s74, s24, 573440
    s_addc_u32 s75, s25, 0
    s_lshl_b32 s48, s61, 14
    s_lshl_b32 s49, s28, 11
    s_add_u32 s48, s48, s49
    s_lshl_b32 s49, s63, 10
    s_add_u32 s48, s48, s49
    v_add_u32 v12, s48, v199
    v_lshlrev_b32 v13, 7, v5
    v_add_u32 v13, 131072, v13
    s_lshl_b32 s54, s26, 8
    s_lshr_b32 s55, s27, 4
    s_lshl_b32 s48, s26, 11
    s_add_u32 s48, s48, 32768
    s_add_u32 s76, s24, s48
    s_addc_u32 s77, s25, 0
    v_lshlrev_b32 v50, 0, v195
    v_add_u32 v50, s48, v50
    s_lshl_b32 s49, s27, 2
    s_add_u32 s48, s48, s49
    v_mov_b32 v49, s48
    s_lshl_b32 s44, s26, 15
    s_lshl_b32 s49, s55, 14
    s_add_u32 s44, s44, s49
    s_add_u32 s44, s44, 1572864
    s_add_u32 s49, s44, s52
    v_lshlrev_b32 v192, 4, v1
    v_add_u32 v21, s49, v192
    s_lshl_b32 s45, s26, 10
    s_lshl_b32 s49, s55, 9
    s_add_u32 s45, s45, s49
    s_add_u32 s45, s45, 8192
    s_lshl_b32 s49, s61, 6
    s_add_u32 s49, s45, s49
    v_lshl_add_u32 v198, v4, 2, v5
    v_and_b32 v198, 7, v198
    v_lshlrev_b32 v198, 2, v198
    v_lshl_add_u32 v22, v194, 5, v198
    v_add_u32 v22, s49, v22
    s_mul_i32 s48, s61, 320
    s_lshl_b32 s49, s63, 7
    s_add_u32 s48, s48, s49
    s_add_u32 s48, s48, 153152
    v_lshlrev_b32 v25, 3, v5
    v_lshl_add_u32 v25, v4, 1, v25
    v_add_u32 v25, s48, v25
    v_add_u32 v28, 158528, v193
    s_movk_i32 s62, 80
    v_lshl_add_u32 v198, v194, 4, v5
    v_lshlrev_b32 v197, 2, v197
    v_mad_u32_u24 v26, v198, s62, v197
    s_lshl_b32 s48, s30, 3
    s_add_u32 s48, s48, 118784
    v_add_u32 v26, s48, v26
    v_lshlrev_b32 v198, 4, v3
    v_lshl_add_u32 v27, v197, 1, v198
    v_lshl_add_u32 v27, v2, 1, v27
    s_lshl_b32 s48, s30, 6
    s_add_u32 s48, s48, 123904
    v_add_u32 v27, s48, v27
    v_and_b32 v41, 1, v1
    v_lshlrev_b32 v41, 13, v41
    v_bfe_u32 v38, v1, 1, 3
    v_lshl_add_u32 v41, v38, 2, v41
    s_lshr_b32 s48, s60, 1
    s_lshl_b32 s48, s48, 10
    s_and_b32 s49, s60, 1
    s_lshl_b32 s49, s49, 6
    s_add_u32 s48, s48, s49
    s_lshl_b32 s49, s55, 15
    s_add_u32 s48, s48, s49
    s_lshl_b32 s58, s26, 7
    s_add_u32 s48, s48, s58
    v_lshl_add_u32 v38, v197, 12, v41
    v_lshl_add_u32 v38, v194, 5, v38
    v_add_u32 v38, s48, v38
    s_lshl_b32 s48, s28, 14
    s_lshl_b32 s49, s29, 10
    s_add_u32 s48, s48, s49
    s_lshl_b32 s49, s30, 5
    s_add_u32 s48, s48, s49
    s_add_u32 s48, s48, s58
    v_add_u32 v41, s48, v41
    s_lshl_b32 s49, s60, 2
    s_add_u32 s49, s49, s45
    v_lshlrev_b32 v37, 6, v4
    v_add_u32 v37, s49, v37
    s_lshl_b32 s48, s30, 10
    s_add_u32 s48, s48, 154432
    v_add_u32 v33, s48, v192
    s_lshl_b32 s48, s30, 2
    s_add_u32 s48, s48, 158528
    v_add_u32 v34, s48, v198
    s_lshl_b32 s48, s30, 4
    s_add_u32 s48, s48, 158592
    v_lshlrev_b32 v44, 6, v3
    v_lshl_add_u32 v44, v4, 2, v44
    v_add_u32 v44, s48, v44
    v_mul_u32_u24 v40, 80, v1
    v_add_u32 v40, 118784, v40
    v_add_u32 v42, 123904, v193
    s_lshl_b32 s49, s55, 7
    s_add_u32 s49, s49, s54
    s_add_u32 s49, s49, 131072
    v_bfe_u32 v43, v1, 3, 2
    v_lshlrev_b32 v43, 11, v43
    v_lshl_add_u32 v43, v194, 13, v43
    v_and_b32 v46, 7, v1
    v_lshl_add_u32 v43, v46, 4, v43
    v_add_u32 v43, s49, v43
    s_xor_b32 s22, s30, 4
    s_or_b32 s22, s22, s60
    s_cselect_b32 s22, 0, 0x01010101
    s_mov_b32 s23, s22
    v_add_u32 v46, 154432, v192
    s_lshl_b32 s48, s51, 10
    s_add_u32 s48, s48, s44
    s_lshl_b32 s49, s60, 4
    s_add_u32 s48, s48, s49
    v_lshlrev_b32 v47, 12, v4
    v_lshl_add_u32 v47, v3, 8, v47
    v_lshl_add_u32 v47, v2, 2, v47
    v_add_u32 v47, s48, v47
    v_lshl_add_u32 v198, v4, 2, v3
    v_and_b32 v48, 7, v198
    s_lshl_b32 s48, s51, 1
    v_xor_b32 v48, s48, v48
    v_lshlrev_b32 v48, 5, v48
    v_lshl_add_u32 v48, v198, 8, v48
    v_lshl_add_u32 v48, v2, 3, v48
    v_lshl_add_u32 v192, v4, 2, v3
    v_bfe_u32 v193, v192, 1, 2
    v_xor_b32 v193, s51, v193
    v_lshlrev_b32 v193, 5, v193
    v_lshl_add_u32 v193, v192, 7, v193
    v_lshl_add_u32 v193, v2, 3, v193
    s_lshl_b32 s48, s30, 2
    s_add_u32 s48, s48, 158864
    v_mov_b32 v211, s48
    s_waitcnt lgkmcnt(0)
    s_add_u32 s31, s31, 991780647
    s_min_u32 s31, s31, -2
    s_and_b32 s32, s31, 0xff
    s_bfe_u32 s33, s31, 0x80008
    s_bfe_u32 s34, s31, 0x80010
    s_lshr_b32 s35, s31, 24
    v_lshlrev_b32 v168, 3, v2
    v_lshrrev_b32 v6, v168, s31
    v_and_b32 v6, 0xff, v6
    v_mov_b32 v8, s31
    s_mov_b32 s3, s31
    s_waitcnt vmcnt(0)
    ds_write_b32 v23, v166
    ds_write_b32 v23, v167 offset:640
    v_lshlrev_b32 v54, 16, v166
    v_and_b32 v55, 0xffff0000, v166
    v_mov_b32 v210, 1
    ds_write_b32 v211, v210
    v_mov_b32 v209, 158848
    s_mov_b32 s46, 0
Lq_5:
    ds_read_b128 v[200:203], v209
    ds_read_b128 v[204:207], v209 offset:16
    s_add_u32 s46, s46, 1
    s_cmp_gt_u32 s46, 0x100000
    s_cbranch_scc1 Lq_6
    s_waitcnt lgkmcnt(0)
    v_min3_u32 v200, v200, v201, v202
    v_min3_u32 v203, v203, v204, v205
    v_min3_u32 v200, v200, v206, v207
    v_min_u32 v200, v200, v203
    v_cmp_gt_u32 vcc, 1, v200
    s_cbranch_vccnz Lq_5
Lq_6:
    ds_read_b128 v[168:171], v24 offset:0
    ds_read_b128 v[172:175], v24 offset:64
    ds_read_b128 v[176:179], v24 offset:128
    ds_read_b128 v[180:183], v24 offset:192
    ds_read_b64_tr_b16 v[120:121], v193 offset:0
    ds_read_b64_tr_b16 v[122:123], v193 offset:2048
    ds_read_b64_tr_b16 v[124:125], v193 offset:4096
    ds_read_b64_tr_b16 v[126:127], v193 offset:6144
    ds_read_b64_tr_b16 v[128:129], v193 offset:8192
    ds_read_b64_tr_b16 v[130:131], v193 offset:10240
    ds_read_b64_tr_b16 v[132:133], v193 offset:12288
    ds_read_b64_tr_b16 v[134:135], v193 offset:14336
    s_waitcnt lgkmcnt(0)
    v_mfma_f32_16x16x32_bf16 v[184:187], v[168:171], v[120:123], 0
    s_waitcnt lgkmcnt(0)
    v_mfma_f32_16x16x32_bf16 v[184:187], v[172:175], v[124:127], v[184:187]
    s_waitcnt lgkmcnt(0)
    v_mfma_f32_16x16x32_bf16 v[184:187], v[176:179], v[128:131], v[184:187]
    s_waitcnt lgkmcnt(0)
    v_mfma_f32_16x16x32_bf16 v[184:187], v[180:183], v[132:135], v[184:187]
    v_add_u32 v188, 32768, v35
    s_cmp_eq_u32 s37, 0
    s_nop 5
    v_and_or_b32 v184, v184, s36, v6
    v_and_or_b32 v185, v185, s36, v6
    global_store_dword v35, v184, s[38:39]
    s_mov_b64 exec, 0xffff
    global_store_dword v188, v185, s[38:39]
    s_mov_b64 exec, -1
    v_mov_b32 v140, v184
    v_mov_b32 v141, v185
    s_mov_b32 s89, 0
    s_cmp_lg_u32 s30, 3
    s_cbranch_scc1 La_7
    ds_read_b128 v[168:171], v24 offset:0
    ds_read_b128 v[172:175], v24 offset:64
    ds_read_b128 v[176:179], v24 offset:128
    ds_read_b128 v[180:183], v24 offset:192
    s_lshl_b32 s48, s47, 8
    s_or_b32 s48, s48, s34
    s_waitcnt lgkmcnt(3)
    v_mfma_f32_16x16x32_bf16 v[184:187], v[168:171], v[168:171], 0
    s_waitcnt lgkmcnt(2)
    v_mfma_f32_16x16x32_bf16 v[184:187], v[172:175], v[172:175], v[184:187]
    s_waitcnt lgkmcnt(1)
    v_mfma_f32_16x16x32_bf16 v[184:187], v[176:179], v[176:179], v[184:187]
    s_waitcnt lgkmcnt(0)
    v_mfma_f32_16x16x32_bf16 v[184:187], v[180:183], v[180:183], v[184:187]
    v_mov_b32 v188, s32
    v_mov_b32 v189, s33
    v_mov_b32 v190, s48
    v_mov_b32 v191, s35
    s_mov_b64 exec, s[14:15]
    s_cmp_eq_u32 s37, 0
    s_nop 1
    v_and_or_b32 v188, v184, s36, v188
    v_and_or_b32 v189, v185, s36, v189
    global_store_dwordx4 v45, v[188:191], s[38:39]
    s_mov_b64 exec, -1
    v_mov_b32 v144, v188
    v_mov_b32 v145, v189
    v_mov_b32 v146, v190
    v_mov_b32 v147, v191
    s_mov_b64 exec, -1
    v_lshlrev_b32 v199, 7, v1
    v_add_u32 v199, s27, v199
    s_mov_b64 exec, 255
    global_store_byte v199, v8, s[76:77] offset:1024
    s_mov_b64 exec, -1
La_7:
    s_sub_u32 s48, s30, 0
    s_cmp_gt_u32 s48, 2
    s_cbranch_scc1 Lw_11
    s_mov_b32 s42, 0x01010101
    s_mov_b32 s43, 0x01010101
    s_mov_b64 exec, s[42:43]
    global_load_dword v215, v30, s[24:25]
    s_mov_b64 exec, -1
Lw_11:
    s_mul_i32 s78, s32, 0x01010101
    s_mov_b32 s79, s78
    v_add_u32 v196, 0x1000, v14
    v_add_u32 v197, 0x1000, v15
    v_lshl_add_u32 v198, v4, 8, v16
    v_xor_b32 v192, v4, v5
    v_lshlrev_b32 v192, 4, v192
    v_lshl_add_u32 v192, v5, 8, v192
    s_lshl_b32 s48, s30, 13
    s_add_u32 s48, s48, 118784
    v_add_u32 v192, s48, v192
    v_xor_b32 v193, 64, v192
    v_xor_b32 v194, 0x80, v192
    v_xor_b32 v195, 0xc0, v192
    s_cmp_lg_u32 s30, 0
    s_cbranch_scc1 Lw_13
    s_call_b64 s[94:95], L_pad0
    s_branch Lw_12
Lw_13:
    s_cmp_lg_u32 s30, 1
    s_cbranch_scc1 Lw_14
    s_call_b64 s[94:95], L_pad1
    s_branch Lw_12
Lw_14:
    s_cmp_lg_u32 s30, 2
    s_cbranch_scc1 Lw_15
    s_call_b64 s[94:95], L_pad2
    s_branch Lw_12
Lw_15:
    s_call_b64 s[94:95], L_pad3
Lw_12:
    s_sleep 1
    s_load_dwordx8 s[80:87], s[76:77], 1024
    s_waitcnt lgkmcnt(0)
    s_xor_b64 s[80:81], s[80:81], s[78:79]
    s_xor_b64 s[82:83], s[82:83], s[78:79]
    s_xor_b64 s[84:85], s[84:85], s[78:79]
    s_xor_b64 s[86:87], s[86:87], s[78:79]
    s_or_b64 s[80:81], s[80:81], s[82:83]
    s_or_b64 s[84:85], s[84:85], s[86:87]
    s_or_b64 s[80:81], s[80:81], s[84:85]
    s_cbranch_scc0 Ln_9
    s_sleep 3
    s_load_dwordx8 s[80:87], s[76:77], 1152
    s_waitcnt lgkmcnt(0)
    s_xor_b64 s[80:81], s[80:81], s[78:79]
    s_xor_b64 s[82:83], s[82:83], s[78:79]
    s_xor_b64 s[84:85], s[84:85], s[78:79]
    s_xor_b64 s[86:87], s[86:87], s[78:79]
    s_or_b64 s[80:81], s[80:81], s[82:83]
    s_or_b64 s[84:85], s[84:85], s[86:87]
    s_or_b64 s[80:81], s[80:81], s[84:85]
    s_cbranch_scc0 Ln_9
    s_sleep 3
    s_load_dwordx8 s[80:87], s[76:77], 1280
    s_waitcnt lgkmcnt(0)
    s_xor_b64 s[80:81], s[80:81], s[78:79]
    s_xor_b64 s[82:83], s[82:83], s[78:79]
    s_xor_b64 s[84:85], s[84:85], s[78:79]
    s_xor_b64 s[86:87], s[86:87], s[78:79]
    s_or_b64 s[80:81], s[80:81], s[82:83]
    s_or_b64 s[84:85], s[84:85], s[86:87]
    s_or_b64 s[80:81], s[80:81], s[84:85]
    s_cbranch_scc0 Ln_9
    s_sleep 3
    s_load_dwordx8 s[80:87], s[76:77], 1408
    s_waitcnt lgkmcnt(0)
    s_xor_b64 s[80:81], s[80:81], s[78:79]
    s_xor_b64 s[82:83], s[82:83], s[78:79]
    s_xor_b64 s[84:85], s[84:85], s[78:79]
    s_xor_b64 s[86:87], s[86:87], s[78:79]
    s_or_b64 s[80:81], s[80:81], s[82:83]
    s_or_b64 s[84:85], s[84:85], s[86:87]
    s_or_b64 s[80:81], s[80:81], s[84:85]
    s_cbranch_scc0 Ln_9
    s_sleep 3
    s_load_dwordx8 s[80:87], s[76:77], 1536
    s_waitcnt lgkmcnt(0)
    s_xor_b64 s[80:81], s[80:81], s[78:79]
    s_xor_b64 s[82:83], s[82:83], s[78:79]
    s_xor_b64 s[84:85], s[84:85], s[78:79]
    s_xor_b64 s[86:87], s[86:87], s[78:79]
    s_or_b64 s[80:81], s[80:81], s[82:83]
    s_or_b64 s[84:85], s[84:85], s[86:87]
    s_or_b64 s[80:81], s[80:81], s[84:85]
    s_cbranch_scc0 Ln_9
    s_sleep 3
    s_load_dwordx8 s[80:87], s[76:77], 1664
    s_waitcnt lgkmcnt(0)
    s_xor_b64 s[80:81], s[80:81], s[78:79]
    s_xor_b64 s[82:83], s[82:83], s[78:79]
    s_xor_b64 s[84:85], s[84:85], s[78:79]
    s_xor_b64 s[86:87], s[86:87], s[78:79]
    s_or_b64 s[80:81], s[80:81], s[82:83]
    s_or_b64 s[84:85], s[84:85], s[86:87]
    s_or_b64 s[80:81], s[80:81], s[84:85]
    s_cbranch_scc0 Ln_9
    s_sleep 3
    s_load_dwordx8 s[80:87], s[76:77], 1792
    s_waitcnt lgkmcnt(0)
    s_xor_b64 s[80:81], s[80:81], s[78:79]
    s_xor_b64 s[82:83], s[82:83], s[78:79]
    s_xor_b64 s[84:85], s[84:85], s[78:79]
    s_xor_b64 s[86:87], s[86:87], s[78:79]
    s_or_b64 s[80:81], s[80:81], s[82:83]
    s_or_b64 s[84:85], s[84:85], s[86:87]
    s_or_b64 s[80:81], s[80:81], s[84:85]
    s_cbranch_scc0 Ln_9
    s_sleep 3
    s_load_dwordx8 s[80:87], s[76:77], 1920
    s_waitcnt lgkmcnt(0)
    s_xor_b64 s[80:81], s[80:81], s[78:79]
    s_xor_b64 s[82:83], s[82:83], s[78:79]
    s_xor_b64 s[84:85], s[84:85], s[78:79]
    s_xor_b64 s[86:87], s[86:87], s[78:79]
    s_or_b64 s[80:81], s[80:81], s[82:83]
    s_or_b64 s[84:85], s[84:85], s[86:87]
    s_or_b64 s[80:81], s[80:81], s[84:85]
    s_cbranch_scc0 Ln_9
Ln_9:
    s_mov_b32 s46, 0
    v_mov_b32 v162, v6
    s_mov_b64 exec, 0xffffffff
    global_load_dword v162, v198, s[38:39] sc1
    s_mov_b64 exec, -1
    global_load_dwordx4 v[152:155], v14, s[38:39] sc1
    global_load_dwordx4 v[156:159], v15, s[38:39] sc1
    global_load_dwordx4 v[168:171], v196, s[38:39] sc1
    global_load_dwordx4 v[172:175], v197, s[38:39] sc1
    v_mov_b32 v164, 0x3b000000
    s_waitcnt vmcnt(0)
Lp_17:
    v_xor_b32 v162, v6, v162
    v_xor_b32 v152, s32, v152
    v_xor_b32 v153, s33, v153
    v_xor_b32 v154, s34, v154
    v_xor_b32 v155, s35, v155
    v_xor_b32 v156, s32, v156
    v_xor_b32 v157, s33, v157
    v_xor_b32 v158, s34, v158
    v_xor_b32 v159, s35, v159
    v_xor_b32 v168, s32, v168
    v_xor_b32 v169, s33, v169
    v_xor_b32 v170, s34, v170
    v_xor_b32 v171, s35, v171
    v_xor_b32 v172, s32, v172
    v_xor_b32 v173, s33, v173
    v_xor_b32 v174, s34, v174
    v_xor_b32 v175, s35, v175
    v_add_f32_dpp v163, v162, v162 row_ror:4 row_mask:0xf bank_mask:0xf
    v_or3_b32 v160, v152, v153, v154
    v_or3_b32 v160, v160, v155, v162
    v_add_f32_dpp v163, v163, v163 row_ror:8 row_mask:0xf bank_mask:0xf
    v_or3_b32 v160, v160, v156, v157
    v_or3_b32 v160, v160, v158, v159
    v_or3_b32 v160, v160, v168, v169
    v_or3_b32 v160, v160, v170, v171
    v_or3_b32 v160, v160, v172, v173
    v_or3_b32 v160, v160, v174, v175
    v_readlane_b32 s65, v163, 1
    v_readlane_b32 s64, v163, 0
    v_cmp_ne_u32_sdwa vcc, v160, v7 src0_sel:BYTE_0 src1_sel:DWORD
    v_permlane32_swap_b32 v152, v154
    v_permlane32_swap_b32 v153, v155
    v_pk_add_f32 v[152:153], v[152:153], v[154:155]
    s_nop 1
    v_permlane16_swap_b32 v152, v153
    v_add_f32 v152, v152, v153
    v_permlane32_swap_b32 v156, v158
    v_permlane32_swap_b32 v157, v159
    v_pk_add_f32 v[156:157], v[156:157], v[158:159]
    s_nop 1
    v_permlane16_swap_b32 v156, v157
    v_add_f32 v156, v156, v157
    v_permlane32_swap_b32 v168, v170
    v_permlane32_swap_b32 v169, v171
    v_pk_add_f32 v[168:169], v[168:169], v[170:171]
    s_nop 1
    v_permlane16_swap_b32 v168, v169
    v_add_f32 v168, v168, v169
    v_permlane32_swap_b32 v172, v174
    v_permlane32_swap_b32 v173, v175
    v_pk_add_f32 v[172:173], v[172:173], v[174:175]
    s_nop 1
    v_permlane16_swap_b32 v172, v173
    v_add_f32 v172, v172, v173
    v_mul_f32 v165, s65, v164
    v_mov_b32 v56, v156
    v_fma_f32 v152, -v165, v156, v152
    v_fma_f32 v168, -v165, v172, v168
    v_cvt_pk_bf16_f32 v156, v152, v152
    v_cvt_pk_bf16_f32 v157, v168, v168
    s_cbranch_vccnz Lr_18
Ld_19:
    ds_write_b16 v25, v156
    ds_write_b16 v25, v157 offset:640
    s_lshl_b32 s48, s30, 8
    s_add_u32 s48, s48, 158912
    v_lshlrev_b32 v166, 2, v1
    v_add_u32 v166, s48, v166
    ds_write_b32 v166, v172
    s_lshl_b32 s48, s47, 8
    v_cmp_ne_u32 vcc, s48, v162
    s_and_b32 s48, vcc_lo, 0x44444444
    s_cselect_b32 s48, 0, 1
    v_mov_b32 v166, s48
    ds_write_b32 v211, v166 offset:16
    v_mov_b32 v210, 2
    ds_write_b32 v211, v210
    v_mul_f32 v164, s64, v164
    v_fma_f32 v164, -v165, v165, v164
    v_max_f32 v164, 0, v164
    v_add_f32 v164, 0x3727c5ac, v164
    v_rsq_f32 v164, v164
    v_mov_b32 v209, 158848
    s_mov_b32 s46, 0
Lq_22:
    ds_read_b128 v[200:203], v209
    ds_read_b128 v[204:207], v209 offset:16
    s_add_u32 s46, s46, 1
    s_cmp_gt_u32 s46, 0x100000
    s_cbranch_scc1 Lq_23
    s_cmp_eq_u32 s46, 64
    s_cbranch_scc1 Lq_24
Lq_25:
    s_waitcnt lgkmcnt(0)
    v_min3_u32 v200, v200, v201, v202
    v_min3_u32 v203, v203, v204, v205
    v_min3_u32 v200, v200, v206, v207
    v_min_u32 v200, v200, v203
    v_cmp_gt_u32 vcc, 2, v200
    s_cbranch_vccnz Lq_22
Lq_23:
    ds_read_b128 v[204:207], v209 offset:32
    ds_read_b128 v[60:63], v192 offset:0
    ds_read_b128 v[64:67], v193 offset:0
    ds_read_b128 v[68:71], v194 offset:0
    ds_read_b128 v[72:75], v195 offset:0
    ds_read_b128 v[76:79], v192 offset:4096
    ds_read_b128 v[80:83], v193 offset:4096
    ds_read_b128 v[84:87], v194 offset:4096
    ds_read_b128 v[88:91], v195 offset:4096
    ds_read_b128 v[168:171], v32 offset:0
    ds_read_b128 v[172:175], v32 offset:64
    ds_read_b128 v[176:179], v32 offset:128
    ds_read_b128 v[180:183], v32 offset:192
    v_mul_f32 v58, 0x3e0293ee, v164
    s_waitcnt lgkmcnt(3)
    v_mfma_f32_16x16x32_bf16 v[184:187], v[60:63], v[168:171], 0
    v_mfma_f32_16x16x32_bf16 v[188:191], v[76:79], v[168:171], 0
    s_waitcnt lgkmcnt(2)
    v_mfma_f32_16x16x32_bf16 v[184:187], v[64:67], v[172:175], v[184:187]
    v_mfma_f32_16x16x32_bf16 v[188:191], v[80:83], v[172:175], v[188:191]
    s_waitcnt lgkmcnt(1)
    v_mfma_f32_16x16x32_bf16 v[184:187], v[68:71], v[176:179], v[184:187]
    v_mfma_f32_16x16x32_bf16 v[188:191], v[84:87], v[176:179], v[188:191]
    s_waitcnt lgkmcnt(0)
    v_mfma_f32_16x16x32_bf16 v[184:187], v[72:75], v[180:183], v[184:187]
    v_mfma_f32_16x16x32_bf16 v[188:191], v[88:91], v[180:183], v[188:191]
    s_nop 6
    v_max3_f32 v152, v184, v185, v186
    v_max3_f32 v153, v188, v189, v190
    v_max3_f32 v154, v152, v187, v191
    v_max_f32 v152, v154, v153
    v_max_f32 v153, v154, v153
    s_nop 1
    v_permlane32_swap_b32 v152, v153
    v_max_f32 v154, v152, v153
    v_max_f32 v155, v152, v153
    s_nop 1
    v_permlane16_swap_b32 v154, v155
    v_max_f32 v152, v154, v155
    v_mul_f32 v152, v152, v58
    v_fma_f32 v184, v184, v58, -v152
    v_fma_f32 v185, v185, v58, -v152
    v_fma_f32 v186, v186, v58, -v152
    v_fma_f32 v187, v187, v58, -v152
    v_fma_f32 v188, v188, v58, -v152
    v_fma_f32 v189, v189, v58, -v152
    v_fma_f32 v190, v190, v58, -v152
    v_fma_f32 v191, v191, v58, -v152
    ds_write_b32 v34, v152
    v_exp_f32 v184, v184
    v_exp_f32 v185, v185
    v_exp_f32 v186, v186
    v_exp_f32 v187, v187
    v_exp_f32 v188, v188
    v_exp_f32 v189, v189
    v_exp_f32 v190, v190
    v_exp_f32 v191, v191
    v_cvt_pk_bf16_f32 v156, v184, v185
    v_cvt_pk_bf16_f32 v157, v186, v187
    v_cvt_pk_bf16_f32 v158, v188, v189
    v_cvt_pk_bf16_f32 v159, v190, v191
    ds_write_b128 v33, v[156:159]
    v_pk_add_f32 v[184:185], v[184:185], v[186:187]
    v_pk_add_f32 v[188:189], v[188:189], v[190:191]
    v_pk_add_f32 v[184:185], v[184:185], v[188:189]
    v_add_f32 v184, v184, v185
    ds_write_b32 v44, v184
    v_mov_b32 v210, 3
    ds_write_b32 v211, v210
    v_and_b32 v204, v204, v205
    v_and_b32 v206, v206, v207
    v_and_b32 v204, v204, v206
    s_nop 0
    v_readfirstlane_b32 s37, v204
    s_nop 0
    s_cmp_eq_u32 s37, 0
    s_cselect_b64 s[38:39], s[40:41], s[24:25]
    s_cbranch_scc1 Lt_27
Lt_28:
    v_mov_b32 v209, 158848
    s_mov_b32 s46, 0
Lq_31:
    ds_read_b128 v[200:203], v209
    ds_read_b128 v[204:207], v209 offset:16
    s_add_u32 s46, s46, 1
    s_cmp_gt_u32 s46, 0x100000
    s_cbranch_scc1 Lq_32
    s_waitcnt lgkmcnt(0)
    v_min3_u32 v200, v200, v201, v202
    v_min3_u32 v203, v203, v204, v205
    v_min3_u32 v200, v200, v206, v207
    v_min_u32 v200, v200, v203
    v_cmp_gt_u32 vcc, 3, v200
    s_cbranch_vccnz Lq_31
Lq_32:
    ds_read_b128 v[168:171], v46
    ds_read_b128 v[152:155], v28
    ds_read_b128 v[172:175], v46 offset:1024
    ds_read_b128 v[176:179], v46 offset:2048
    ds_read_b128 v[180:183], v46 offset:3072
    v_xor_b32 v212, 32, v48
    ds_read_b64_tr_b16 v[92:93], v48 offset:16384
    ds_read_b64_tr_b16 v[94:95], v48 offset:20480
    ds_read_b64_tr_b16 v[108:109], v212 offset:16384
    ds_read_b64_tr_b16 v[110:111], v212 offset:20480
    ds_read_b64_tr_b16 v[96:97], v48 offset:24576
    ds_read_b64_tr_b16 v[98:99], v48 offset:28672
    ds_read_b64_tr_b16 v[112:113], v212 offset:24576
    ds_read_b64_tr_b16 v[114:115], v212 offset:28672
    ds_read_b64_tr_b16 v[100:101], v48 offset:32768
    ds_read_b64_tr_b16 v[102:103], v48 offset:36864
    ds_read_b64_tr_b16 v[116:117], v212 offset:32768
    ds_read_b64_tr_b16 v[118:119], v212 offset:36864
    ds_read_b64_tr_b16 v[104:105], v48 offset:40960
    ds_read_b64_tr_b16 v[106:107], v48 offset:45056
    ds_read_b64_tr_b16 v[136:137], v212 offset:40960
    ds_read_b64_tr_b16 v[138:139], v212 offset:45056
    s_waitcnt lgkmcnt(12)
    v_mfma_f32_16x16x32_bf16 v[184:187], v[168:171], v[92:95], 0
    v_mfma_f32_16x16x32_bf16 v[200:203], v[168:171], v[108:111], 0
    s_waitcnt lgkmcnt(8)
    v_mfma_f32_16x16x32_bf16 v[188:191], v[172:175], v[96:99], 0
    v_max3_f32 v160, v152, v153, v154
    v_max_f32 v160, v160, v155
    v_mfma_f32_16x16x32_bf16 v[204:207], v[172:175], v[112:115], 0
    v_sub_f32 v152, v152, v160
    v_sub_f32 v153, v153, v160
    s_waitcnt lgkmcnt(4)
    v_mfma_f32_16x16x32_bf16 v[192:195], v[176:179], v[100:103], 0
    v_sub_f32 v154, v154, v160
    v_sub_f32 v155, v155, v160
    v_mfma_f32_16x16x32_bf16 v[208:211], v[176:179], v[116:119], 0
    v_exp_f32 v152, v152
    s_waitcnt lgkmcnt(0)
    v_mfma_f32_16x16x32_bf16 v[196:199], v[180:183], v[104:107], 0
    v_exp_f32 v153, v153
    v_mfma_f32_16x16x32_bf16 v[212:215], v[180:183], v[136:139], 0
    v_exp_f32 v154, v154
    v_exp_f32 v155, v155
    v_mul_f32 v164, v152, v184
    v_mul_f32 v165, v152, v200
    v_fmac_f32 v164, v153, v188
    v_fmac_f32 v165, v153, v204
    v_fmac_f32 v164, v154, v192
    v_fmac_f32 v165, v154, v208
    v_fmac_f32 v164, v155, v196
    v_fmac_f32 v165, v155, v212
    s_cmp_eq_u32 s37, 0
    v_cvt_pk_bf16_f32 v164, v164, v165
    v_min_u32 v164, -2, v164
    s_cbranch_scc1 Ls_33
    global_store_dword v47, v164, s[24:25]
Ls_34:
    s_cmp_lg_u32 s30, 1
    s_cbranch_scc1 Lm_35
    v_lshlrev_b32 v166, 6, v4
    v_add_u32 v166, 158592, v166
    s_mov_b32 s42, 0x00010001
    s_mov_b32 s43, 0x00010001
    s_mov_b64 exec, s[42:43]
    s_cmp_eq_u32 s37, 0
    ds_read_b128 v[168:171], v166 offset:0
    ds_read_b128 v[172:175], v166 offset:16
    ds_read_b128 v[176:179], v166 offset:32
    ds_read_b128 v[180:183], v166 offset:48
    v_min_u32 v160, -2, v160
    s_waitcnt lgkmcnt(0)
    v_pk_add_f32 v[168:169], v[168:169], v[170:171]
    v_pk_add_f32 v[172:173], v[172:173], v[174:175]
    v_pk_add_f32 v[176:177], v[176:177], v[178:179]
    v_pk_add_f32 v[180:181], v[180:181], v[182:183]
    v_pk_mul_f32 v[168:169], v[168:169], v[152:153] op_sel_hi:[1,0]
    v_pk_fma_f32 v[168:169], v[172:173], v[152:153], v[168:169] op_sel:[0,1,0] op_sel_hi:[1,1,1]
    v_pk_fma_f32 v[168:169], v[176:177], v[154:155], v[168:169] op_sel_hi:[1,0,1]
    v_pk_fma_f32 v[168:169], v[180:181], v[154:155], v[168:169] op_sel:[0,1,0] op_sel_hi:[1,1,1]
    v_add_f32 v161, v168, v169
    v_min_u32 v161, -2, v161
    s_cbranch_scc1 Ls_37
    global_store_dword v37, v160, s[24:25]
    global_store_dword v37, v161, s[24:25] offset:256
Ls_38:
    s_mov_b64 exec, -1
Lm_36:
    s_lshr_b32 s48, s26, 2
    s_xor_b32 s48, s48, 0
    s_lshl_b32 s88, s48, 13
    v_add_u32 v12, s88, v12
    v_add_u32 v13, s88, v13
    s_setprio 1
    s_waitcnt vmcnt(0)
    s_barrier
    s_mov_b32 s46, 0
    global_load_dword v160, v22, s[24:25] sc1
    global_load_dword v165, v22, s[24:25] offset:256 sc1
    global_load_dwordx4 v[152:155], v21, s[24:25] sc1
    global_load_dwordx4 v[156:159], v21, s[24:25] offset:1024 sc1
    v_and_b32 v192, 1, v3
    v_lshlrev_b32 v192, 4, v192
    v_lshl_add_u32 v192, v4, 2, v192
    v_lshrrev_b32 v193, 1, v3
    v_add_u32 v192, v192, v193
    v_and_b32 v193, 1, v4
    v_lshlrev_b32 v193, 5, v193
    v_lshl_add_u32 v193, v192, 6, v193
    v_lshl_add_u32 v193, v2, 3, v193
    s_lshl_b32 s48, s30, 12
    s_add_u32 s48, s48, 49152
    v_add_u32 v193, s48, v193
    v_xor_b32 v194, 32, v193
    ds_read_b64_tr_b16 v[136:137], v193 offset:0
    ds_read_b64_tr_b16 v[138:139], v193 offset:128
    ds_read_b64_tr_b16 v[140:141], v193 offset:2048
    ds_read_b64_tr_b16 v[142:143], v193 offset:2176
    ds_read_b64_tr_b16 v[144:145], v194 offset:0
    ds_read_b64_tr_b16 v[146:147], v194 offset:128
    ds_read_b64_tr_b16 v[148:149], v194 offset:2048
    ds_read_b64_tr_b16 v[150:151], v194 offset:2176
    s_waitcnt lgkmcnt(0)
Lp_43:
    s_waitcnt vmcnt(2)
    v_max_f32_dpp v161, v160, v160 row_ror:1 row_mask:0xf bank_mask:0xf
    v_max_u32 v166, v160, v165
    s_nop 0
    v_max_f32_dpp v161, v161, v161 row_ror:2 row_mask:0xf bank_mask:0xf
    s_waitcnt vmcnt(1)
    v_mfma_f32_16x16x32_bf16 v[168:171], v[152:155], v[136:139], 0
    v_max_f32_dpp v161, v161, v161 row_ror:4 row_mask:0xf bank_mask:0xf
    v_sub_f32 v164, v160, v161
    v_mfma_f32_16x16x32_bf16 v[172:175], v[152:155], v[144:147], 0
    v_exp_f32 v164, v164
    s_waitcnt vmcnt(0)
    v_mfma_f32_16x16x32_bf16 v[168:171], v[156:159], v[140:143], v[168:171]
    v_mul_f32 v161, v164, v165
    v_max3_u32 v162, v152, v153, v154
    v_mfma_f32_16x16x32_bf16 v[172:175], v[156:159], v[148:151], v[172:175]
    v_add_f32_dpp v161, v161, v161 row_ror:1 row_mask:0xf bank_mask:0xf
    v_max3_u32 v163, v155, v156, v157
    v_max3_u32 v162, v162, v158, v159
    v_add_f32_dpp v161, v161, v161 row_ror:2 row_mask:0xf bank_mask:0xf
    v_max3_u32 v162, v162, v163, v166
    v_cmp_eq_u32 vcc, -1, v162
    v_add_f32_dpp v161, v161, v161 row_ror:4 row_mask:0xf bank_mask:0xf
    v_mul_f32_dpp v162, v164, v168 row_newbcast:0 row_mask:0xf bank_mask:0xf
    v_rcp_f32 v161, v161
    s_cbranch_vccnz Lr_44
Ld_45:
    v_fmac_f32_dpp v162, v164, v169 row_newbcast:1 row_mask:0xf bank_mask:0xf
    v_fmac_f32_dpp v162, v164, v170 row_newbcast:2 row_mask:0xf bank_mask:0xf
    v_fmac_f32_dpp v162, v164, v171 row_newbcast:3 row_mask:0xf bank_mask:0xf
    v_mul_f32_dpp v163, v164, v172 row_newbcast:0 row_mask:0xf bank_mask:0xf
    v_mul_f32 v162, v162, v161
    v_fmac_f32_dpp v163, v164, v173 row_newbcast:1 row_mask:0xf bank_mask:0xf
    ds_write_b32 v26, v162
    v_fmac_f32_dpp v163, v164, v174 row_newbcast:2 row_mask:0xf bank_mask:0xf
    v_fmac_f32_dpp v163, v164, v175 row_newbcast:3 row_mask:0xf bank_mask:0xf
    v_mul_f32 v163, v163, v161
    ds_write_b32 v26, v163 offset:2560
    s_cmp_eq_u32 s30, 0
    s_cbranch_scc0 Lk_47
    s_waitcnt lgkmcnt(0)
    s_barrier
    ds_read_b128 v[152:155], v40 offset:0
    ds_read_b128 v[156:159], v40 offset:16
    ds_read_b128 v[160:163], v40 offset:32
    ds_read_b128 v[164:167], v40 offset:48
    s_waitcnt lgkmcnt(2)
    v_pk_add_f32 v[152:153], v[152:153], v[156:157]
    v_pk_add_f32 v[154:155], v[154:155], v[158:159]
    v_pk_add_f32 v[152:153], v[152:153], v[154:155]
    s_waitcnt lgkmcnt(0)
    v_pk_add_f32 v[160:161], v[160:161], v[164:165]
    v_pk_add_f32 v[162:163], v[162:163], v[166:167]
    v_pk_add_f32 v[152:153], v[152:153], v[160:161]
    v_pk_add_f32 v[152:153], v[152:153], v[162:163]
    v_add_f32 v152, v152, v153
    s_nop 1
    v_mov_b32_dpp v153, v152 quad_perm:[0,0,2,2] row_mask:0xf bank_mask:0xf
    v_mov_b32_dpp v154, v152 quad_perm:[1,1,3,3] row_mask:0xf bank_mask:0xf
    v_cvt_pk_bf16_f32 v152, v153, v154
    v_min_u32 v152, -2, v152
    global_store_dword v38, v152, s[68:69] sc1
    v_add_u32 v21, 262144, v21
    v_add_u32 v22, 8192, v22
    v_add_u32 v37, 8192, v37
    v_mov_b32 v153, 158896
    s_mov_b32 s46, 0
Lq_48:
    ds_read_b32 v152, v153
    s_add_u32 s46, s46, 1
    s_cmp_gt_u32 s46, 0x10000
    s_cbranch_scc1 Lq_49
    s_waitcnt lgkmcnt(0)
    v_cmp_eq_u32 vcc, 0, v152
    s_cbranch_vccnz Lq_48
Lq_49:
    s_waitcnt lgkmcnt(0)
    s_movk_i32 s48, 0x2000
    v_bfi_b32 v12, s48, v152, v12
    v_bfi_b32 v13, s48, v152, v13
    s_barrier
    s_mov_b64 exec, -1
    s_branch Lj_46
L_pad1:
    s_branch L_pad5
Lk_47:
    s_cmp_eq_u32 s30, 3
    s_cbranch_scc0 Lk_50
    v_add_u32 v21, 262144, v21
    v_add_u32 v22, 8192, v22
    v_add_u32 v37, 8192, v37
    s_mov_b32 s46, 0
    s_mov_b64 exec, 0xffff
    v_add_u32 v182, 4096, v13
    s_waitcnt lgkmcnt(0)
    s_barrier
    s_nop 15
    s_nop 15
    s_nop 7
    global_load_dword v9, v13, s[68:69] offset:0 sc1
    s_nop 15
    s_nop 15
    s_nop 2
    global_load_dword v18, v13, s[68:69] offset:2048 sc1
    s_waitcnt vmcnt(1)
    v_cmp_ne_u32 vcc, s31, v9
    s_cbranch_vccz Ld_52
    s_add_u32 s46, s46, 1
    global_load_dword v9, v182, s[68:69] offset:0 sc1
    s_waitcnt vmcnt(1)
    v_cmp_ne_u32 vcc, s31, v18
    s_cbranch_vccz Ld_52
    s_add_u32 s46, s46, 1
    global_load_dword v18, v182, s[68:69] offset:2048 sc1
Lp_51:
    s_waitcnt vmcnt(1)
    v_cmp_ne_u32 vcc, s31, v9
    s_cbranch_vccz Ld_52
    s_add_u32 s46, s46, 1
    global_load_dword v9, v182, s[68:69] offset:2048 sc1
    s_waitcnt vmcnt(1)
    v_cmp_ne_u32 vcc, s31, v18
    s_cbranch_vccz Ld_52
    s_add_u32 s46, s46, 1
    global_load_dword v18, v182, s[68:69] offset:2048 sc1
    s_cmp_lt_u32 s46, 0x8000
    s_cbranch_scc1 Lp_51
Ld_52:
    s_barrier
    s_mov_b64 exec, -1
    v_mov_b32 v153, 158896
    s_mov_b32 s46, 0
Lq_53:
    ds_read_b32 v152, v153
    s_add_u32 s46, s46, 1
    s_cmp_gt_u32 s46, 0x10000
    s_cbranch_scc1 Lq_54
    s_waitcnt lgkmcnt(0)
    v_cmp_eq_u32 vcc, 0, v152
    s_cbranch_vccnz Lq_53
Lq_54:
    s_waitcnt lgkmcnt(0)
    s_movk_i32 s48, 0x2000
    v_bfi_b32 v12, s48, v152, v12
    v_bfi_b32 v13, s48, v152, v13
    s_branch Lj_46
L_pad2:
    s_branch L_pad6
Lk_50:
    s_cmp_eq_u32 s30, 1
    s_cbranch_scc0 Lk_55
    s_waitcnt lgkmcnt(0)
    s_barrier
    s_lshr_b32 s48, s2, 6
    s_lshl_b32 s48, s48, 14
    s_and_b32 s49, s2, 63
    s_lshl_b32 s49, s49, 7
    s_add_u32 s48, s48, s49
    s_add_u32 s48, s48, 65536
    s_add_u32 s78, s24, s48
    s_addc_u32 s79, s25, 0
    s_memtime s[80:81]
    s_waitcnt lgkmcnt(0)
    s_load_dword s86, s[78:79], 0 glc
    s_waitcnt lgkmcnt(0)
    s_memtime s[82:83]
    s_waitcnt lgkmcnt(0)
    s_sub_u32 s84, s82, s80
    s_cmp_gt_u32 s84, 480
    s_cselect_b32 s48, 0x2001, 1
    v_mov_b32 v152, s48
    v_mov_b32 v153, 158896
    v_mov_b32 v154, s84
    ds_write_b32 v153, v154 offset:8
    ds_write_b32 v153, v152
    v_add_u32 v21, 262144, v21
    v_add_u32 v22, 8192, v22
    v_add_u32 v37, 8192, v37
    v_mov_b32 v153, 158896
    s_mov_b32 s46, 0
Lq_56:
    ds_read_b32 v152, v153
    s_add_u32 s46, s46, 1
    s_cmp_gt_u32 s46, 0x10000
    s_cbranch_scc1 Lq_57
    s_waitcnt lgkmcnt(0)
    v_cmp_eq_u32 vcc, 0, v152
    s_cbranch_vccnz Lq_56
Lq_57:
    s_waitcnt lgkmcnt(0)
    s_movk_i32 s48, 0x2000
    v_bfi_b32 v12, s48, v152, v12
    v_bfi_b32 v13, s48, v152, v13
    s_barrier
    s_mov_b64 exec, -1
    s_branch Lj_46
L_pad3:
    s_branch L_pad7
Lk_55:
    s_waitcnt lgkmcnt(0)
    s_barrier
    v_add_u32 v21, 262144, v21
    v_add_u32 v22, 8192, v22
    v_add_u32 v37, 8192, v37
    v_mov_b32 v153, 158896
    s_mov_b32 s46, 0
Lq_58:
    ds_read_b32 v152, v153
    s_add_u32 s46, s46, 1
    s_cmp_gt_u32 s46, 0x10000
    s_cbranch_scc1 Lq_59
    s_waitcnt lgkmcnt(0)
    v_cmp_eq_u32 vcc, 0, v152
    s_cbranch_vccnz Lq_58
Lq_59:
    s_waitcnt lgkmcnt(0)
    s_movk_i32 s48, 0x2000
    v_bfi_b32 v12, s48, v152, v12
    v_bfi_b32 v13, s48, v152, v13
    s_barrier
Lj_46:
    s_mov_b32 s46, 0
    global_load_dwordx4 v[152:155], v12, s[68:69] sc1
    s_waitcnt vmcnt(0)
Lp_60:
    v_lshlrev_b32 v156, 16, v152
    v_and_b32 v157, 0xffff0000, v152
    v_lshlrev_b32 v160, 16, v154
    v_and_b32 v161, 0xffff0000, v154
    v_lshlrev_b32 v158, 16, v153
    v_and_b32 v159, 0xffff0000, v153
    v_lshlrev_b32 v162, 16, v155
    v_and_b32 v163, 0xffff0000, v155
    v_permlane32_swap_b32 v156, v160
    v_permlane32_swap_b32 v157, v161
    v_permlane32_swap_b32 v158, v162
    v_permlane32_swap_b32 v159, v163
    v_pk_add_f32 v[156:157], v[156:157], v[160:161]
    v_pk_add_f32 v[158:159], v[158:159], v[162:163]
    v_max3_u32 v152, v152, v153, v154
    s_nop 0
    v_permlane16_swap_b32 v156, v158
    v_permlane16_swap_b32 v157, v159
    v_pk_add_f32 v[156:157], v[156:157], v[158:159]
    v_max_u32 v152, v152, v155
    v_cmp_eq_u32 vcc, -1, v152
    v_add_f32_dpp v158, v156, v156 row_ror:8 row_mask:0xf bank_mask:0xf
    v_add_f32_dpp v159, v157, v157 row_ror:8 row_mask:0xf bank_mask:0xf
    v_pk_add_f32 v[158:159], v[158:159], v[54:55]
    v_cvt_pk_bf16_f32 v166, v158, v159
    s_cbranch_vccnz Lr_61
Ld_62:
    ds_write_b32 v23, v166
    v_lshlrev_b32 v54, 16, v166
    v_and_b32 v55, 0xffff0000, v166
    s_xor_b32 s48, s30, 2
    s_or_b32 s48, s48, s92
    s_cmp_eq_u32 s48, 0
    s_cbranch_scc0 Lk_64
    s_waitcnt lgkmcnt(0)
    s_barrier
    ds_read_b128 v[168:171], v24 offset:0
    ds_read_b128 v[172:175], v24 offset:64
    ds_read_b128 v[176:179], v24 offset:128
    ds_read_b128 v[180:183], v24 offset:192
    s_lshl_b32 s48, s47, 8
    s_or_b32 s48, s48, s34
    s_waitcnt lgkmcnt(3)
    v_mfma_f32_16x16x32_bf16 v[184:187], v[168:171], v[168:171], 0
    s_waitcnt lgkmcnt(2)
    v_mfma_f32_16x16x32_bf16 v[184:187], v[172:175], v[172:175], v[184:187]
    s_waitcnt lgkmcnt(1)
    v_mfma_f32_16x16x32_bf16 v[184:187], v[176:179], v[176:179], v[184:187]
    s_waitcnt lgkmcnt(0)
    v_mfma_f32_16x16x32_bf16 v[184:187], v[180:183], v[180:183], v[184:187]
    v_mov_b32 v188, s32
    v_mov_b32 v189, s33
    v_mov_b32 v190, s48
    v_mov_b32 v191, s35
    s_mov_b64 exec, s[14:15]
    s_cmp_eq_u32 s37, 0
    s_nop 1
    v_and_or_b32 v188, v184, s36, v188
    v_and_or_b32 v189, v185, s36, v189
    s_cbranch_scc1 Ls_65
    global_store_dwordx4 v36, v[188:191], s[24:25]
Ls_66:
    s_mov_b64 exec, -1
    s_barrier
    s_mov_b64 exec, -1
    s_branch Lj_63
L_pad4:
    s_branch L_pad8
Lk_64:
    s_cmp_eq_u32 s30, 3
    s_cbranch_scc0 Lk_67
    s_add_u32 s49, s3, 2
    v_mov_b32 v9, s49
    s_mov_b32 s42, -1
    s_mov_b32 s43, 0
    s_mov_b64 exec, 1
    s_cmp_eq_u32 s37, 0
    s_waitcnt lgkmcnt(0)
    s_barrier
    s_nop 4
    s_cbranch_scc1 Ls_68
    global_store_dword v49, v9, s[24:25]
Ls_69:
    s_mov_b64 exec, s[42:43]
    s_nop 15
    s_nop 3
    s_mov_b32 s46, 0
    global_load_dword v9, v50, s[24:25] sc1
    s_nop 13
    global_load_dword v18, v50, s[24:25] sc1
    s_nop 13
    global_load_dword v51, v50, s[24:25] sc1
    s_nop 13
    global_load_dword v52, v50, s[24:25] sc1
Lp_70:
    s_waitcnt vmcnt(3)
    v_subrev_u32 v9, s49, v9
    v_cmp_le_u32 vcc, 8, v9
    s_cbranch_vccz Ld_71
    global_load_dword v9, v50, s[24:25] sc1
    s_add_u32 s46, s46, 1
    s_waitcnt vmcnt(3)
    v_subrev_u32 v18, s49, v18
    v_cmp_le_u32 vcc, 8, v18
    s_cbranch_vccz Ld_71
    global_load_dword v18, v50, s[24:25] sc1
    s_add_u32 s46, s46, 1
    s_waitcnt vmcnt(3)
    v_subrev_u32 v51, s49, v51
    v_cmp_le_u32 vcc, 8, v51
    s_cbranch_vccz Ld_71
    global_load_dword v51, v50, s[24:25] sc1
    s_add_u32 s46, s46, 1
    s_waitcnt vmcnt(3)
    v_subrev_u32 v52, s49, v52
    v_cmp_le_u32 vcc, 8, v52
    s_cbranch_vccz Ld_71
    global_load_dword v52, v50, s[24:25] sc1
    s_add_u32 s46, s46, 1
    s_cmp_lt_u32 s46, 0x10000
    s_cbranch_scc1 Lp_70
Ld_71:
    s_barrier
    s_mov_b64 exec, -1
    s_branch Lj_63
L_pad5:
    s_branch L_pad9
Lk_67:
    s_waitcnt lgkmcnt(0)
    s_barrier
    s_barrier
Lj_63:
    s_mov_b32 s46, 0
    global_load_dword v162, v20, s[24:25] sc1
    global_load_dword v152, v17, s[24:25] sc1
    global_load_dword v153, v17, s[24:25] offset:256 sc1
    global_load_dword v154, v19, s[24:25] sc1
    global_load_dword v155, v19, s[24:25] offset:256 sc1
    v_mov_b32 v164, 0x3b000000
    v_lshl_add_u32 v192, v4, 2, v3
    v_bfe_u32 v193, v192, 1, 2
    v_xor_b32 v193, s51, v193
    v_lshlrev_b32 v193, 5, v193
    v_lshl_add_u32 v193, v192, 7, v193
    v_lshl_add_u32 v193, v2, 3, v193
    v_add_u32 v193, 90112, v193
    ds_read_b64_tr_b16 v[92:93], v193 offset:0
    ds_read_b64_tr_b16 v[94:95], v193 offset:2048
    ds_read_b64_tr_b16 v[96:97], v193 offset:4096
    ds_read_b64_tr_b16 v[98:99], v193 offset:6144
    ds_read_b64_tr_b16 v[100:101], v193 offset:8192
    ds_read_b64_tr_b16 v[102:103], v193 offset:10240
    ds_read_b64_tr_b16 v[104:105], v193 offset:12288
    ds_read_b64_tr_b16 v[106:107], v193 offset:14336
    ds_read_b64_tr_b16 v[108:109], v193 offset:16384
    ds_read_b64_tr_b16 v[110:111], v193 offset:18432
    ds_read_b64_tr_b16 v[112:113], v193 offset:20480
    ds_read_b64_tr_b16 v[114:115], v193 offset:22528
    ds_read_b64_tr_b16 v[116:117], v193 offset:24576
    ds_read_b64_tr_b16 v[118:119], v193 offset:26624
    s_waitcnt vmcnt(0)
Lp_74:
    v_xor_b32 v162, v6, v162
    v_xor_b32 v152, v6, v152
    v_xor_b32 v153, v6, v153
    v_add_f32_dpp v163, v162, v162 row_ror:4 row_mask:0xf bank_mask:0xf
    v_add_f32 v156, v152, v153
    v_add_f32 v157, v152, v153
    v_add_f32_dpp v163, v163, v163 row_ror:8 row_mask:0xf bank_mask:0xf
    v_or3_b32 v160, v152, v153, v162
    v_permlane32_swap_b32 v156, v157
    v_xor_b32 v154, v6, v154
    v_xor_b32 v155, v6, v155
    v_add_f32 v158, v154, v155
    v_add_f32 v159, v154, v155
    v_or3_b32 v160, v160, v154, v155
    s_nop 0
    v_permlane32_swap_b32 v158, v159
    v_add_f32 v57, v158, v159
    v_mul_f32_dpp v165, v163, v164 row_newbcast:1 row_mask:0xf bank_mask:0xf
    v_mul_f32_dpp v164, v163, v164 row_newbcast:0 row_mask:0xf bank_mask:0xf
    v_cmp_ne_u32_sdwa vcc, v160, v7 src0_sel:BYTE_0 src1_sel:DWORD
    v_fma_f32 v164, -v165, v165, v164
    v_add_f32 v152, v156, v157
    v_max_f32 v164, 0, v164
    v_add_f32 v164, 0x3727c5ac, v164
    v_rsq_f32 v164, v164
    v_fma_f32 v152, -v165, v57, v152
    s_cbranch_vccnz Lr_75
Ld_76:
    v_mul_f32 v152, v152, v164
    v_mul_f32 v153, 0xbfb8aa3b, v152
    v_exp_f32 v153, v153
    s_nop 0
    v_add_f32 v153, 1.0, v153
    v_rcp_f32 v153, v153
    s_nop 0
    v_mul_f32 v152, v152, v153
    v_cvt_pk_bf16_f32 v152, v152, v152
    ds_write_b16 v27, v152
    s_sub_u32 s48, s30, 0
    s_cmp_le_u32 s48, 2
    s_cbranch_scc1 Lx_77
    s_mov_b32 s42, 0x01010101
    s_mov_b32 s43, 0x01010101
    s_mov_b64 exec, s[42:43]
    global_load_dword v215, v30, s[24:25]
    s_mov_b64 exec, -1
Lx_77:
Le_72:
    s_waitcnt lgkmcnt(0)
    s_barrier
    ds_read_b128 v[152:155], v42 offset:0
    ds_read_b128 v[156:159], v42 offset:64
    ds_read_b128 v[160:163], v42 offset:128
    ds_read_b128 v[164:167], v42 offset:192
    ds_read_b128 v[168:171], v42 offset:256
    ds_read_b128 v[172:175], v42 offset:320
    ds_read_b128 v[176:179], v42 offset:384
    s_waitcnt lgkmcnt(6)
    v_mfma_f32_16x16x32_bf16 v[184:187], v[152:155], v[92:95], 0
    s_waitcnt lgkmcnt(5)
    v_mfma_f32_16x16x32_bf16 v[184:187], v[156:159], v[96:99], v[184:187]
    s_waitcnt lgkmcnt(4)
    v_mfma_f32_16x16x32_bf16 v[184:187], v[160:163], v[100:103], v[184:187]
    s_waitcnt lgkmcnt(3)
    v_mfma_f32_16x16x32_bf16 v[184:187], v[164:167], v[104:107], v[184:187]
    s_waitcnt lgkmcnt(2)
    v_mfma_f32_16x16x32_bf16 v[184:187], v[168:171], v[108:111], v[184:187]
    s_waitcnt lgkmcnt(1)
    v_mfma_f32_16x16x32_bf16 v[184:187], v[172:175], v[112:115], v[184:187]
    s_waitcnt lgkmcnt(0)
    v_mfma_f32_16x16x32_bf16 v[184:187], v[176:179], v[116:119], v[184:187]
    s_nop 6
    s_mov_b64 exec, 0xffff
    v_mov_b32_dpp v185, v184 quad_perm:[0,0,2,2] row_mask:0xf bank_mask:0xf
    v_mov_b32_dpp v186, v184 quad_perm:[1,1,3,3] row_mask:0xf bank_mask:0xf
    v_cvt_pk_bf16_f32 v184, v185, v186
    v_min_u32 v184, -2, v184
    global_store_dword v41, v184, s[70:71] sc1
    s_mov_b64 exec, -1
    v_mov_b32 v153, 158900
    s_mov_b32 s46, 0
Lq_79:
    ds_read_b32 v152, v153
    s_add_u32 s46, s46, 1
    s_cmp_gt_u32 s46, 0x10000
    s_cbranch_scc1 Lq_80
    s_waitcnt lgkmcnt(0)
    v_cmp_eq_u32 vcc, 0, v152
    s_cbranch_vccnz Lq_79
Lq_80:
    s_waitcnt lgkmcnt(0)
    s_movk_i32 s48, 0x2000
    v_bfi_b32 v12, s48, v152, v12
    v_bfi_b32 v13, s48, v152, v13
    s_barrier
Lj_78:
    s_mov_b32 s46, 0
    global_load_dwordx4 v[152:155], v12, s[70:71] sc1
    s_waitcnt vmcnt(0)
Lp_81:
    v_lshlrev_b32 v156, 16, v152
    v_and_b32 v157, 0xffff0000, v152
    v_lshlrev_b32 v160, 16, v154
    v_and_b32 v161, 0xffff0000, v154
    v_lshlrev_b32 v158, 16, v153
    v_and_b32 v159, 0xffff0000, v153
    v_lshlrev_b32 v162, 16, v155
    v_and_b32 v163, 0xffff0000, v155
    v_permlane32_swap_b32 v156, v160
    v_permlane32_swap_b32 v157, v161
    v_permlane32_swap_b32 v158, v162
    v_permlane32_swap_b32 v159, v163
    v_pk_add_f32 v[156:157], v[156:157], v[160:161]
    v_pk_add_f32 v[158:159], v[158:159], v[162:163]
    v_max3_u32 v152, v152, v153, v154
    s_nop 0
    v_permlane16_swap_b32 v156, v158
    v_permlane16_swap_b32 v157, v159
    v_pk_add_f32 v[156:157], v[156:157], v[158:159]
    v_max_u32 v152, v152, v155
    v_cmp_eq_u32 vcc, -1, v152
    v_add_f32_dpp v158, v156, v156 row_ror:8 row_mask:0xf bank_mask:0xf
    v_add_f32_dpp v159, v157, v157 row_ror:8 row_mask:0xf bank_mask:0xf
    v_pk_add_f32 v[158:159], v[158:159], v[54:55]
    v_cvt_pk_bf16_f32 v166, v158, v159
    s_cbranch_vccnz Lr_82
Ld_83:
    ds_write_b32 v23, v166
    v_lshlrev_b32 v54, 16, v166
    v_and_b32 v55, 0xffff0000, v166
    s_add_u32 s31, s31, 991780647
    s_min_u32 s31, s31, -2
    s_and_b32 s32, s31, 0xff
    s_bfe_u32 s33, s31, 0x80008
    s_bfe_u32 s34, s31, 0x80010
    s_lshr_b32 s35, s31, 24
    v_lshlrev_b32 v168, 3, v2
    v_lshrrev_b32 v6, v168, s31
    v_and_b32 v6, 0xff, v6
    v_mov_b32 v8, s31
    s_waitcnt lgkmcnt(0)
    s_barrier
    ds_read_b128 v[168:171], v24 offset:0
    ds_read_b128 v[172:175], v24 offset:64
    ds_read_b128 v[176:179], v24 offset:128
    ds_read_b128 v[180:183], v24 offset:192
    s_waitcnt lgkmcnt(3)
    v_mfma_f32_16x16x32_bf16 v[184:187], v[168:171], v[120:123], 0
    s_waitcnt lgkmcnt(2)
    v_mfma_f32_16x16x32_bf16 v[184:187], v[172:175], v[124:127], v[184:187]
    s_waitcnt lgkmcnt(1)
    v_mfma_f32_16x16x32_bf16 v[184:187], v[176:179], v[128:131], v[184:187]
    s_waitcnt lgkmcnt(0)
    v_mfma_f32_16x16x32_bf16 v[184:187], v[180:183], v[132:135], v[184:187]
    s_cmp_eq_u32 s37, 0
    s_nop 6
    v_and_or_b32 v184, v184, s36, v6
    s_cbranch_scc1 Ls_85
    global_store_dword v35, v184, s[38:39]
Ls_86:
    s_barrier
Lj_84:
    s_mov_b32 s46, 0
    global_load_dword v162, v16, s[38:39] sc1
    global_load_dwordx4 v[152:155], v14, s[38:39] sc1
    v_mov_b32 v164, 0x3b000000
    s_waitcnt vmcnt(0)
Lp_87:
    v_xor_b32 v162, v6, v162
    v_xor_b32 v152, s32, v152
    v_xor_b32 v153, s33, v153
    v_xor_b32 v154, s34, v154
    v_xor_b32 v155, s35, v155
    v_add_f32_dpp v163, v162, v162 row_ror:4 row_mask:0xf bank_mask:0xf
    v_or3_b32 v160, v152, v153, v154
    v_or3_b32 v160, v160, v155, v162
    v_add_f32_dpp v163, v163, v163 row_ror:8 row_mask:0xf bank_mask:0xf
    v_permlane32_swap_b32 v152, v154
    v_permlane32_swap_b32 v153, v155
    v_pk_add_f32 v[152:153], v[152:153], v[154:155]
    v_cmp_ne_u32_sdwa vcc, v160, v7 src0_sel:BYTE_0 src1_sel:DWORD
    v_mul_f32_dpp v165, v163, v164 row_newbcast:1 row_mask:0xf bank_mask:0xf
    v_permlane16_swap_b32 v152, v153
    v_add_f32 v152, v152, v153
    v_fma_f32 v152, -v165, v56, v152
    v_cvt_pk_bf16_f32 v156, v152, v152
    s_cbranch_vccnz Lr_88
Ld_89:
    ds_write_b16 v25, v156
    v_mul_f32_dpp v164, v163, v164 row_newbcast:0 row_mask:0xf bank_mask:0xf
    v_fma_f32 v164, -v165, v165, v164
    v_max_f32 v164, 0, v164
    v_add_f32 v164, 0x3727c5ac, v164
    v_rsq_f32 v164, v164
    s_waitcnt lgkmcnt(0)
    s_barrier
    ds_read_b128 v[168:171], v32 offset:0
    ds_read_b128 v[172:175], v32 offset:64
    ds_read_b128 v[176:179], v32 offset:128
    ds_read_b128 v[180:183], v32 offset:192
    v_mul_f32 v58, 0x3e0293ee, v164
    s_waitcnt lgkmcnt(3)
    v_mfma_f32_16x16x32_bf16 v[184:187], v[60:63], v[168:171], 0
    v_mfma_f32_16x16x32_bf16 v[188:191], v[76:79], v[168:171], 0
    s_waitcnt lgkmcnt(2)
    v_mfma_f32_16x16x32_bf16 v[184:187], v[64:67], v[172:175], v[184:187]
    v_mfma_f32_16x16x32_bf16 v[188:191], v[80:83], v[172:175], v[188:191]
    s_waitcnt lgkmcnt(1)
    v_mfma_f32_16x16x32_bf16 v[184:187], v[68:71], v[176:179], v[184:187]
    v_mfma_f32_16x16x32_bf16 v[188:191], v[84:87], v[176:179], v[188:191]
    s_waitcnt lgkmcnt(0)
    v_mfma_f32_16x16x32_bf16 v[184:187], v[72:75], v[180:183], v[184:187]
    v_mfma_f32_16x16x32_bf16 v[188:191], v[88:91], v[180:183], v[188:191]
    s_nop 6
    v_max3_f32 v152, v184, v185, v186
    v_max3_f32 v153, v188, v189, v190
    v_max3_f32 v154, v152, v187, v191
    v_max_f32 v152, v154, v153
    v_max_f32 v153, v154, v153
    s_nop 1
    v_permlane32_swap_b32 v152, v153
    v_max_f32 v154, v152, v153
    v_max_f32 v155, v152, v153
    s_nop 1
    v_permlane16_swap_b32 v154, v155
    v_max_f32 v152, v154, v155
    v_mul_f32 v152, v152, v58
    v_fma_f32 v184, v184, v58, -v152
    v_fma_f32 v185, v185, v58, -v152
    v_fma_f32 v186, v186, v58, -v152
    v_fma_f32 v187, v187, v58, -v152
    v_fma_f32 v188, v188, v58, -v152
    v_fma_f32 v189, v189, v58, -v152
    v_fma_f32 v190, v190, v58, -v152
    v_fma_f32 v191, v191, v58, -v152
    ds_write_b32 v34, v152
    v_exp_f32 v184, v184
    v_exp_f32 v185, v185
    v_exp_f32 v186, v186
    v_exp_f32 v187, v187
    v_exp_f32 v188, v188
    v_exp_f32 v189, v189
    v_exp_f32 v190, v190
    v_exp_f32 v191, v191
    v_cvt_pk_bf16_f32 v156, v184, v185
    v_cvt_pk_bf16_f32 v157, v186, v187
    v_cvt_pk_bf16_f32 v158, v188, v189
    v_cvt_pk_bf16_f32 v159, v190, v191
    ds_write_b128 v33, v[156:159]
    v_pk_add_f32 v[184:185], v[184:185], v[186:187]
    v_pk_add_f32 v[188:189], v[188:189], v[190:191]
    v_pk_add_f32 v[184:185], v[184:185], v[188:189]
    v_add_f32 v184, v184, v185
    ds_write_b32 v44, v184
    s_cmp_eq_u32 s30, 1
    s_cbranch_scc0 Lk_91
    v_lshlrev_b32 v166, 6, v4
    v_add_u32 v166, 158592, v166
    s_mov_b32 s42, 0x00010001
    s_mov_b32 s43, 0x00010001
    s_mov_b64 exec, s[42:43]
    s_cmp_eq_u32 s37, 0
    s_waitcnt lgkmcnt(0)
    s_barrier
    ds_read_b128 v[152:155], v28
    ds_read_b128 v[168:171], v166 offset:0
    ds_read_b128 v[172:175], v166 offset:16
    ds_read_b128 v[176:179], v166 offset:32
    ds_read_b128 v[180:183], v166 offset:48
    s_waitcnt lgkmcnt(4)
    v_max3_f32 v160, v152, v153, v154
    v_max_f32 v160, v160, v155
    v_sub_f32 v152, v152, v160
    v_sub_f32 v153, v153, v160
    v_sub_f32 v154, v154, v160
    v_sub_f32 v155, v155, v160
    v_exp_f32 v152, v152
    v_exp_f32 v153, v153
    v_exp_f32 v154, v154
    v_exp_f32 v155, v155
    v_min_u32 v160, -2, v160
    s_waitcnt lgkmcnt(0)
    v_pk_add_f32 v[168:169], v[168:169], v[170:171]
    v_pk_add_f32 v[172:173], v[172:173], v[174:175]
    v_pk_add_f32 v[176:177], v[176:177], v[178:179]
    v_pk_add_f32 v[180:181], v[180:181], v[182:183]
    v_pk_mul_f32 v[168:169], v[168:169], v[152:153] op_sel_hi:[1,0]
    v_pk_fma_f32 v[168:169], v[172:173], v[152:153], v[168:169] op_sel:[0,1,0] op_sel_hi:[1,1,1]
    v_pk_fma_f32 v[168:169], v[176:177], v[154:155], v[168:169] op_sel_hi:[1,0,1]
    v_pk_fma_f32 v[168:169], v[180:181], v[154:155], v[168:169] op_sel:[0,1,0] op_sel_hi:[1,1,1]
    v_add_f32 v161, v168, v169
    v_min_u32 v161, -2, v161
    s_cbranch_scc1 Ls_92
    global_store_dword v37, v160, s[24:25]
    global_store_dword v37, v161, s[24:25] offset:256
Ls_93:
    s_mov_b64 exec, -1
    s_barrier
    s_mov_b64 exec, -1
    s_branch Lj_90
L_pad6:
    s_branch L_pad10
Lk_91:
    s_cmp_eq_u32 s30, 2
    s_cbranch_scc0 Lk_94
    s_add_u32 s49, s3, 4
    v_mov_b32 v9, s49
    s_lshl_b32 s48, s55, 4
    s_lshl_b32 s42, 0xffff, s48
    s_mov_b32 s43, 0
    s_mov_b64 exec, 1
    s_cmp_eq_u32 s37, 0
    s_waitcnt lgkmcnt(0)
    s_barrier
    s_nop 15
    s_nop 15
    s_nop 15
    s_nop 1
    s_cbranch_scc1 Ls_95
    global_store_dword v49, v9, s[24:25]
Ls_96:
    s_mov_b64 exec, s[42:43]
    s_nop 15
    s_nop 3
    s_mov_b32 s46, 0
    global_load_dword v9, v50, s[24:25] sc1
    s_nop 13
    global_load_dword v18, v50, s[24:25] sc1
    s_nop 13
    global_load_dword v51, v50, s[24:25] sc1
    s_nop 13
    global_load_dword v52, v50, s[24:25] sc1
Lp_97:
    s_waitcnt vmcnt(3)
    v_subrev_u32 v9, s49, v9
    v_cmp_le_u32 vcc, 8, v9
    s_cbranch_vccz Ld_98
    global_load_dword v9, v50, s[24:25] sc1
    s_add_u32 s46, s46, 1
    s_waitcnt vmcnt(3)
    v_subrev_u32 v18, s49, v18
    v_cmp_le_u32 vcc, 8, v18
    s_cbranch_vccz Ld_98
    global_load_dword v18, v50, s[24:25] sc1
    s_add_u32 s46, s46, 1
    s_waitcnt vmcnt(3)
    v_subrev_u32 v51, s49, v51
    v_cmp_le_u32 vcc, 8, v51
    s_cbranch_vccz Ld_98
    global_load_dword v51, v50, s[24:25] sc1
    s_add_u32 s46, s46, 1
    s_waitcnt vmcnt(3)
    v_subrev_u32 v52, s49, v52
    v_cmp_le_u32 vcc, 8, v52
    s_cbranch_vccz Ld_98
    global_load_dword v52, v50, s[24:25] sc1
    s_add_u32 s46, s46, 1
    s_cmp_lt_u32 s46, 0x10000
    s_cbranch_scc1 Lp_97
Ld_98:
    s_barrier
    s_mov_b64 exec, -1
    s_branch Lj_90
L_pad7:
    s_branch L_pad11
Lk_94:
    s_waitcnt lgkmcnt(0)
    s_barrier
    s_barrier
Lj_90:
    s_mov_b32 s46, 0
    global_load_dword v160, v22, s[24:25] sc1
    global_load_dword v165, v22, s[24:25] offset:256 sc1
    global_load_dwordx4 v[152:155], v21, s[24:25] sc1
    global_load_dwordx4 v[156:159], v21, s[24:25] offset:1024 sc1
Lp_99:
    s_waitcnt vmcnt(2)
    v_max_f32_dpp v161, v160, v160 row_ror:1 row_mask:0xf bank_mask:0xf
    v_max_u32 v166, v160, v165
    s_nop 0
    v_max_f32_dpp v161, v161, v161 row_ror:2 row_mask:0xf bank_mask:0xf
    s_waitcnt vmcnt(1)
    v_mfma_f32_16x16x32_bf16 v[168:171], v[152:155], v[136:139], 0
    v_max_f32_dpp v161, v161, v161 row_ror:4 row_mask:0xf bank_mask:0xf
    v_sub_f32 v164, v160, v161
    v_mfma_f32_16x16x32_bf16 v[172:175], v[152:155], v[144:147], 0
    v_exp_f32 v164, v164
    s_waitcnt vmcnt(0)
    v_mfma_f32_16x16x32_bf16 v[168:171], v[156:159], v[140:143], v[168:171]
    v_mul_f32 v161, v164, v165
    v_max3_u32 v162, v152, v153, v154
    v_mfma_f32_16x16x32_bf16 v[172:175], v[156:159], v[148:151], v[172:175]
    v_add_f32_dpp v161, v161, v161 row_ror:1 row_mask:0xf bank_mask:0xf
    v_max3_u32 v163, v155, v156, v157
    v_max3_u32 v162, v162, v158, v159
    v_add_f32_dpp v161, v161, v161 row_ror:2 row_mask:0xf bank_mask:0xf
    v_max3_u32 v162, v162, v163, v166
    v_cmp_eq_u32 vcc, -1, v162
    v_add_f32_dpp v161, v161, v161 row_ror:4 row_mask:0xf bank_mask:0xf
    v_mul_f32_dpp v162, v164, v168 row_newbcast:0 row_mask:0xf bank_mask:0xf
    v_rcp_f32 v161, v161
    s_cbranch_vccnz Lr_100
Ld_101:
    v_fmac_f32_dpp v162, v164, v169 row_newbcast:1 row_mask:0xf bank_mask:0xf
    v_fmac_f32_dpp v162, v164, v170 row_newbcast:2 row_mask:0xf bank_mask:0xf
    v_fmac_f32_dpp v162, v164, v171 row_newbcast:3 row_mask:0xf bank_mask:0xf
    v_mul_f32_dpp v163, v164, v172 row_newbcast:0 row_mask:0xf bank_mask:0xf
    v_mul_f32 v162, v162, v161
    v_fmac_f32_dpp v163, v164, v173 row_newbcast:1 row_mask:0xf bank_mask:0xf
    ds_write_b32 v26, v162
    v_fmac_f32_dpp v163, v164, v174 row_newbcast:2 row_mask:0xf bank_mask:0xf
    v_fmac_f32_dpp v163, v164, v175 row_newbcast:3 row_mask:0xf bank_mask:0xf
    v_mul_f32 v163, v163, v161
    ds_write_b32 v26, v163 offset:2560
    s_cmp_eq_u32 s30, 0
    s_cbranch_scc0 Lk_103
    s_waitcnt lgkmcnt(0)
    s_barrier
    ds_read_b128 v[152:155], v40 offset:0
    ds_read_b128 v[156:159], v40 offset:16
    ds_read_b128 v[160:163], v40 offset:32
    ds_read_b128 v[164:167], v40 offset:48
    s_waitcnt lgkmcnt(2)
    v_pk_add_f32 v[152:153], v[152:153], v[156:157]
    v_pk_add_f32 v[154:155], v[154:155], v[158:159]
    v_pk_add_f32 v[152:153], v[152:153], v[154:155]
    s_waitcnt lgkmcnt(0)
    v_pk_add_f32 v[160:161], v[160:161], v[164:165]
    v_pk_add_f32 v[162:163], v[162:163], v[166:167]
    v_pk_add_f32 v[152:153], v[152:153], v[160:161]
    v_pk_add_f32 v[152:153], v[152:153], v[162:163]
    v_add_f32 v152, v152, v153
    s_nop 1
    v_mov_b32_dpp v153, v152 quad_perm:[0,0,2,2] row_mask:0xf bank_mask:0xf
    v_mov_b32_dpp v154, v152 quad_perm:[1,1,3,3] row_mask:0xf bank_mask:0xf
    v_cvt_pk_bf16_f32 v152, v153, v154
    v_min_u32 v152, -2, v152
    global_store_dword v38, v152, s[72:73] sc1
    s_barrier
    s_mov_b64 exec, -1
    s_branch Lj_102
L_pad8:
    s_branch L_pad12
Lk_103:
    s_cmp_eq_u32 s30, 3
    s_cbranch_scc0 Lk_104
    s_mov_b32 s46, 0
    s_mov_b64 exec, 0xffff
    v_add_u32 v182, 4096, v13
    s_waitcnt lgkmcnt(0)
    s_barrier
    s_nop 15
    s_nop 15
    s_nop 7
    global_load_dword v9, v13, s[72:73] offset:0 sc1
    s_nop 15
    s_nop 15
    s_nop 2
    global_load_dword v18, v13, s[72:73] offset:2048 sc1
    s_waitcnt vmcnt(1)
    v_cmp_ne_u32 vcc, s31, v9
    s_cbranch_vccz Ld_106
    s_add_u32 s46, s46, 1
    global_load_dword v9, v182, s[72:73] offset:0 sc1
    s_waitcnt vmcnt(1)
    v_cmp_ne_u32 vcc, s31, v18
    s_cbranch_vccz Ld_106
    s_add_u32 s46, s46, 1
    global_load_dword v18, v182, s[72:73] offset:2048 sc1
Lp_105:
    s_waitcnt vmcnt(1)
    v_cmp_ne_u32 vcc, s31, v9
    s_cbranch_vccz Ld_106
    s_add_u32 s46, s46, 1
    global_load_dword v9, v182, s[72:73] offset:2048 sc1
    s_waitcnt vmcnt(1)
    v_cmp_ne_u32 vcc, s31, v18
    s_cbranch_vccz Ld_106
    s_add_u32 s46, s46, 1
    global_load_dword v18, v182, s[72:73] offset:2048 sc1
    s_cmp_lt_u32 s46, 0x8000
    s_cbranch_scc1 Lp_105
Ld_106:
    s_barrier
    s_mov_b64 exec, -1
    s_branch Lj_102
L_pad9:
    s_branch L_pad13
Lk_104:
    s_waitcnt lgkmcnt(0)
    s_barrier
    s_barrier
Lj_102:
    s_mov_b32 s46, 0
    global_load_dwordx4 v[152:155], v12, s[72:73] sc1
    s_waitcnt vmcnt(0)
Lp_107:
    v_lshlrev_b32 v156, 16, v152
    v_and_b32 v157, 0xffff0000, v152
    v_lshlrev_b32 v160, 16, v154
    v_and_b32 v161, 0xffff0000, v154
    v_lshlrev_b32 v158, 16, v153
    v_and_b32 v159, 0xffff0000, v153
    v_lshlrev_b32 v162, 16, v155
    v_and_b32 v163, 0xffff0000, v155
    v_permlane32_swap_b32 v156, v160
    v_permlane32_swap_b32 v157, v161
    v_permlane32_swap_b32 v158, v162
    v_permlane32_swap_b32 v159, v163
    v_pk_add_f32 v[156:157], v[156:157], v[160:161]
    v_pk_add_f32 v[158:159], v[158:159], v[162:163]
    v_max3_u32 v152, v152, v153, v154
    s_nop 0
    v_permlane16_swap_b32 v156, v158
    v_permlane16_swap_b32 v157, v159
    v_pk_add_f32 v[156:157], v[156:157], v[158:159]
    v_max_u32 v152, v152, v155
    v_cmp_eq_u32 vcc, -1, v152
    v_add_f32_dpp v158, v156, v156 row_ror:8 row_mask:0xf bank_mask:0xf
    v_add_f32_dpp v159, v157, v157 row_ror:8 row_mask:0xf bank_mask:0xf
    v_pk_add_f32 v[158:159], v[158:159], v[54:55]
    v_cvt_pk_bf16_f32 v166, v158, v159
    s_cbranch_vccnz Lr_108
Ld_109:
    ds_write_b32 v23, v166
    v_lshlrev_b32 v54, 16, v166
    v_and_b32 v55, 0xffff0000, v166
    s_xor_b32 s48, s30, 2
    s_or_b32 s48, s48, s92
    s_cmp_eq_u32 s48, 0
    s_cbranch_scc0 Lk_111
    s_waitcnt lgkmcnt(0)
    s_barrier
    ds_read_b128 v[168:171], v24 offset:0
    ds_read_b128 v[172:175], v24 offset:64
    ds_read_b128 v[176:179], v24 offset:128
    ds_read_b128 v[180:183], v24 offset:192
    s_lshl_b32 s48, s47, 8
    s_or_b32 s48, s48, s34
    s_waitcnt lgkmcnt(3)
    v_mfma_f32_16x16x32_bf16 v[184:187], v[168:171], v[168:171], 0
    s_waitcnt lgkmcnt(2)
    v_mfma_f32_16x16x32_bf16 v[184:187], v[172:175], v[172:175], v[184:187]
    s_waitcnt lgkmcnt(1)
    v_mfma_f32_16x16x32_bf16 v[184:187], v[176:179], v[176:179], v[184:187]
    s_waitcnt lgkmcnt(0)
    v_mfma_f32_16x16x32_bf16 v[184:187], v[180:183], v[180:183], v[184:187]
    v_mov_b32 v188, s32
    v_mov_b32 v189, s33
    v_mov_b32 v190, s48
    v_mov_b32 v191, s35
    s_mov_b64 exec, s[14:15]
    s_cmp_eq_u32 s37, 0
    s_nop 1
    v_and_or_b32 v188, v184, s36, v188
    v_and_or_b32 v189, v185, s36, v189
    s_cbranch_scc1 Ls_112
    global_store_dwordx4 v36, v[188:191], s[24:25]
Ls_113:
    s_mov_b64 exec, -1
    s_barrier
    s_mov_b64 exec, -1
    s_branch Lj_110
L_pad10:
    s_branch L_pad14
Lk_111:
    s_cmp_eq_u32 s30, 3
    s_cbranch_scc0 Lk_114
    s_add_u32 s49, s3, 5
    v_mov_b32 v9, s49
    s_mov_b32 s42, -1
    s_mov_b32 s43, 0
    s_mov_b64 exec, 1
    s_cmp_eq_u32 s37, 0
    s_waitcnt lgkmcnt(0)
    s_barrier
    s_cbranch_scc1 Ls_115
    global_store_dword v49, v9, s[24:25]
Ls_116:
    s_mov_b64 exec, s[42:43]
    s_nop 15
    s_nop 3
    s_mov_b32 s46, 0
    global_load_dword v9, v50, s[24:25] sc1
    s_nop 13
    global_load_dword v18, v50, s[24:25] sc1
    s_nop 13
    global_load_dword v51, v50, s[24:25] sc1
    s_nop 13
    global_load_dword v52, v50, s[24:25] sc1
Lp_117:
    s_waitcnt vmcnt(3)
    v_subrev_u32 v9, s49, v9
    v_cmp_le_u32 vcc, 8, v9
    s_cbranch_vccz Ld_118
    global_load_dword v9, v50, s[24:25] sc1
    s_add_u32 s46, s46, 1
    s_waitcnt vmcnt(3)
    v_subrev_u32 v18, s49, v18
    v_cmp_le_u32 vcc, 8, v18
    s_cbranch_vccz Ld_118
    global_load_dword v18, v50, s[24:25] sc1
    s_add_u32 s46, s46, 1
    s_waitcnt vmcnt(3)
    v_subrev_u32 v51, s49, v51
    v_cmp_le_u32 vcc, 8, v51
    s_cbranch_vccz Ld_118
    global_load_dword v51, v50, s[24:25] sc1
    s_add_u32 s46, s46, 1
    s_waitcnt vmcnt(3)
    v_subrev_u32 v52, s49, v52
    v_cmp_le_u32 vcc, 8, v52
    s_cbranch_vccz Ld_118
    global_load_dword v52, v50, s[24:25] sc1
    s_add_u32 s46, s46, 1
    s_cmp_lt_u32 s46, 0x10000
    s_cbranch_scc1 Lp_117
Ld_118:
    s_barrier
    s_mov_b64 exec, -1
    s_branch Lj_110
L_pad11:
    s_branch L_pad15
Lk_114:
    s_waitcnt lgkmcnt(0)
    s_barrier
    s_barrier
Lj_110:
    s_mov_b32 s46, 0
    global_load_dword v162, v20, s[24:25] sc1
    global_load_dword v152, v17, s[24:25] sc1
    global_load_dword v153, v17, s[24:25] offset:256 sc1
    v_mov_b32 v164, 0x3b000000
    s_waitcnt vmcnt(0)
Lp_121:
    v_xor_b32 v162, v6, v162
    v_xor_b32 v152, v6, v152
    v_xor_b32 v153, v6, v153
    v_add_f32_dpp v163, v162, v162 row_ror:4 row_mask:0xf bank_mask:0xf
    v_add_f32 v156, v152, v153
    v_add_f32 v157, v152, v153
    v_add_f32_dpp v163, v163, v163 row_ror:8 row_mask:0xf bank_mask:0xf
    v_or3_b32 v160, v152, v153, v162
    v_permlane32_swap_b32 v156, v157
    v_mul_f32_dpp v165, v163, v164 row_newbcast:1 row_mask:0xf bank_mask:0xf
    v_mul_f32_dpp v164, v163, v164 row_newbcast:0 row_mask:0xf bank_mask:0xf
    v_cmp_ne_u32_sdwa vcc, v160, v7 src0_sel:BYTE_0 src1_sel:DWORD
    v_fma_f32 v164, -v165, v165, v164
    v_add_f32 v152, v156, v157
    v_max_f32 v164, 0, v164
    v_add_f32 v164, 0x3727c5ac, v164
    v_rsq_f32 v164, v164
    v_fma_f32 v152, -v165, v57, v152
    s_cbranch_vccnz Lr_122
Ld_123:
    v_mul_f32 v152, v152, v164
    v_mul_f32 v153, 0xbfb8aa3b, v152
    v_exp_f32 v153, v153
    s_nop 0
    v_add_f32 v153, 1.0, v153
    v_rcp_f32 v153, v153
    s_nop 0
    v_mul_f32 v152, v152, v153
    v_cvt_pk_bf16_f32 v152, v152, v152
    ds_write_b16 v27, v152
Le_119:
    s_waitcnt lgkmcnt(0)
    s_barrier
    ds_read_b128 v[152:155], v42 offset:0
    ds_read_b128 v[156:159], v42 offset:64
    ds_read_b128 v[160:163], v42 offset:128
    ds_read_b128 v[164:167], v42 offset:192
    ds_read_b128 v[168:171], v42 offset:256
    ds_read_b128 v[172:175], v42 offset:320
    ds_read_b128 v[176:179], v42 offset:384
    s_waitcnt lgkmcnt(6)
    v_mfma_f32_16x16x32_bf16 v[184:187], v[152:155], v[92:95], 0
    s_waitcnt lgkmcnt(5)
    v_mfma_f32_16x16x32_bf16 v[184:187], v[156:159], v[96:99], v[184:187]
    s_waitcnt lgkmcnt(4)
    v_mfma_f32_16x16x32_bf16 v[184:187], v[160:163], v[100:103], v[184:187]
    s_waitcnt lgkmcnt(3)
    v_mfma_f32_16x16x32_bf16 v[184:187], v[164:167], v[104:107], v[184:187]
    s_waitcnt lgkmcnt(2)
    v_mfma_f32_16x16x32_bf16 v[184:187], v[168:171], v[108:111], v[184:187]
    s_waitcnt lgkmcnt(1)
    v_mfma_f32_16x16x32_bf16 v[184:187], v[172:175], v[112:115], v[184:187]
    s_waitcnt lgkmcnt(0)
    v_mfma_f32_16x16x32_bf16 v[184:187], v[176:179], v[116:119], v[184:187]
    s_nop 6
    s_mov_b64 exec, 0xffff
    v_mov_b32_dpp v185, v184 quad_perm:[0,0,2,2] row_mask:0xf bank_mask:0xf
    v_mov_b32_dpp v186, v184 quad_perm:[1,1,3,3] row_mask:0xf bank_mask:0xf
    v_cvt_pk_bf16_f32 v184, v185, v186
    v_min_u32 v184, -2, v184
    global_store_dword v41, v184, s[74:75] sc1
    s_mov_b64 exec, -1
    s_cmp_lg_u32 s26, s29
    s_cbranch_scc1 L_fin0
    s_barrier
Lj_124:
    s_cmp_lg_u32 s30, s29
    s_cbranch_scc1 L_fin0
    s_mov_b32 s46, 0
    global_load_dwordx4 v[152:155], v12, s[74:75] sc1
    s_waitcnt vmcnt(0)
Lp_125:
    v_lshlrev_b32 v156, 16, v152
    v_and_b32 v157, 0xffff0000, v152
    v_lshlrev_b32 v160, 16, v154
    v_and_b32 v161, 0xffff0000, v154
    v_lshlrev_b32 v158, 16, v153
    v_and_b32 v159, 0xffff0000, v153
    v_lshlrev_b32 v162, 16, v155
    v_and_b32 v163, 0xffff0000, v155
    v_permlane32_swap_b32 v156, v160
    v_permlane32_swap_b32 v157, v161
    v_permlane32_swap_b32 v158, v162
    v_permlane32_swap_b32 v159, v163
    v_pk_add_f32 v[156:157], v[156:157], v[160:161]
    v_pk_add_f32 v[158:159], v[158:159], v[162:163]
    v_max3_u32 v152, v152, v153, v154
    s_nop 0
    v_permlane16_swap_b32 v156, v158
    v_permlane16_swap_b32 v157, v159
    v_pk_add_f32 v[156:157], v[156:157], v[158:159]
    v_max_u32 v152, v152, v155
    v_cmp_eq_u32 vcc, -1, v152
    v_add_f32_dpp v158, v156, v156 row_ror:8 row_mask:0xf bank_mask:0xf
    v_add_f32_dpp v159, v157, v157 row_ror:8 row_mask:0xf bank_mask:0xf
    v_pk_add_f32 v[158:159], v[158:159], v[54:55]
    v_cvt_pk_bf16_f32 v166, v158, v159
    s_cbranch_vccnz Lr_126
Ld_127:
    s_mov_b32 s42, 0x00ff00ff
    s_mov_b32 s43, 0x00ff00ff
    s_mov_b64 exec, s[42:43]
    global_store_dword v59, v166, s[20:21]
L_fin0:
    s_endpgm
L_role1:
    v_and_b32 v2, 3, v1
    v_bfe_u32 v3, v1, 2, 2
    s_lshr_b32 s61, s30, 1
    s_and_b32 s63, s30, 1
    s_lshl_b32 s48, s28, 8
    s_lshl_b32 s49, s61, 10
    s_add_u32 s48, s48, s49
    s_lshl_b32 s49, s63, 7
    s_add_u32 s48, s48, s49
    v_and_b32 v59, 7, v1
    v_lshlrev_b32 v59, 4, v59
    v_lshl_add_u32 v59, v4, 2, v59
    v_add_u32 v59, s48, v59
    v_and_b32 v5, 15, v1
    s_lshl_b32 s52, s30, 11
    s_lshl_b32 s56, s26, 5
    s_add_u32 s57, s56, s27
    v_mov_b32 v7, 0
    v_lshrrev_b32 v163, 2, v1
    v_and_b32 v164, 1, v4
    v_lshlrev_b32 v164, 1, v164
    v_xor_b32 v164, v164, v2
    v_lshlrev_b32 v164, 4, v164
    v_lshl_add_u32 v35, v163, 10, v164
    s_lshl_b32 s48, s26, 19
    s_lshl_b32 s49, s51, 14
    s_add_u32 s48, s48, s49
    s_and_b32 s49, s27, 15
    s_lshl_b32 s49, s49, 6
    s_add_u32 s48, s48, s49
    v_add_u32 v35, s48, v35
    s_lshr_b32 s91, s27, 3
    s_and_b32 s91, s91, 2
    s_and_b32 s49, s27, 1
    s_or_b32 s91, s91, s49
    s_lshl_b32 s50, s28, 23
    s_lshl_b32 s49, s26, 20
    s_add_u32 s50, s50, s49
    s_add_u32 s50, s50, 0xC0000
    v_lshl_add_u32 v29, v153, 10, v154
    s_lshl_b32 s48, s51, 2
    v_add_u32 v162, s48, v4
    v_xor_b32 v33, v162, v5
    v_lshlrev_b32 v33, 4, v33
    v_lshl_add_u32 v33, v162, 8, v33
    v_and_b32 v32, 7, v162
    v_lshlrev_b32 v32, 1, v32
    v_xor_b32 v32, v32, v5
    v_lshlrev_b32 v32, 4, v32
    v_lshl_add_u32 v32, v162, 8, v32
    s_movk_i32 s48, 3584
    v_mad_u32_u24 v36, v163, s48, v164
    s_lshl_b32 s48, s28, 7
    s_lshl_b32 s49, s51, 4
    s_add_u32 s48, s48, s49
    s_mul_i32 s48, s48, 3584
    s_mul_i32 s49, s26, 448
    s_add_u32 s48, s48, s49
    s_min_u32 s49, s29, 6
    s_lshl_b32 s49, s49, 6
    s_add_u32 s48, s48, s49
    v_add_u32 v36, s48, v36
    s_mul_i32 s48, s26, 229376
    s_lshl_b32 s49, s29, 7
    s_add_u32 s48, s48, s49
    v_add_u32 v29, s48, v29
    s_barrier
    s_lshl_b32 s48, s51, 2
    s_add_u32 s48, s48, 158848
    v_mov_b32 v211, s48
    s_add_u32 s94, s29, 0
    s_and_b32 s94, s94, 7
    s_lshl_b32 s94, s94, 12
    s_add_u32 s94, s94, s50
    s_add_u32 m0, s53, 118784
    v_add_u32 v213, s94, v33
    global_load_lds_dwordx4 v213, s[6:7] nt
    s_load_dword s31, s[24:25], 0
    s_getreg_b32 s47, hwreg(HW_REG_XCC_ID, 0, 4)
    s_mov_b32 s36, 0xffffff00
    s_mov_b32 s37, 0
    s_mov_b64 s[38:39], s[24:25]
    s_add_u32 s40, s24, 2097152
    s_addc_u32 s41, s25, 0
    s_movk_i32 s62, 320
    s_mul_i32 s48, s61, 320
    s_lshl_b32 s49, s63, 7
    s_add_u32 s48, s48, s49
    s_add_u32 s48, s48, 151552
    v_bfe_u32 v192, v1, 2, 1
    v_lshlrev_b32 v23, 6, v192
    v_and_b32 v192, 1, v1
    v_lshl_add_u32 v23, v192, 5, v23
    v_lshrrev_b32 v192, 5, v1
    v_lshl_add_u32 v23, v192, 4, v23
    v_bfe_u32 v192, v1, 1, 1
    v_lshl_add_u32 v23, v192, 3, v23
    v_bfe_u32 v192, v1, 4, 1
    v_lshl_add_u32 v23, v192, 2, v23
    v_add_u32 v23, s48, v23
    v_lshlrev_b32 v193, 4, v4
    v_mad_u32_u24 v197, v3, s62, v193
    v_add_u32 v24, 151552, v197
    v_mov_b32 v194, 152832
    v_cmp_ne_u32 vcc, 0, v2
    s_lshl_b32 s66, s26, 16
    s_add_u32 s66, s66, 1048576
    v_cndmask_b32 v24, v24, v194, vcc
    s_lshl_b32 s67, s26, 15
    s_add_u32 s67, s67, 786432
    v_lshlrev_b32 v196, 2, v5
    s_lshl_b32 s48, s29, 6
    s_lshl_b32 s49, s28, 4
    s_add_u32 s94, s29, 1
    s_and_b32 s94, s94, 7
    s_lshl_b32 s94, s94, 12
    s_add_u32 s94, s94, s50
    s_add_u32 s94, s94, 32768
    s_add_u32 m0, s53, 126976
    v_add_u32 v213, s94, v33
    s_waitcnt vmcnt(4)
    global_load_lds_dwordx4 v213, s[6:7] nt
    s_add_u32 s48, s48, s49
    s_add_u32 s49, s48, s66
    s_add_u32 s49, s49, 0xA000
    v_lshlrev_b32 v194, 9, v4
    v_add_u32 v45, s49, v194
    s_mov_b32 s14, 0x00100001
    s_mov_b32 s15, 0x10000100
    s_lshl_b32 s58, s51, 6
    s_and_b32 s60, s27, 15
    s_add_u32 s92, s29, 1
    s_lshr_b32 s92, s92, 3
    s_lshl_b32 s48, s29, 2
    s_add_u32 s94, s29, 2
    s_and_b32 s94, s94, 7
    s_lshl_b32 s94, s94, 12
    s_add_u32 s94, s94, s50
    s_add_u32 s94, s94, 65536
    s_add_u32 m0, s53, 135168
    v_add_u32 v213, s94, v33
    s_waitcnt vmcnt(4)
    global_load_lds_dwordx4 v213, s[6:7] nt
    s_add_u32 s48, s48, s28
    s_lshl_b32 s49, s48, 7
    s_add_u32 s49, s49, s58
    s_add_u32 s49, s49, s67
    v_lshl_add_u32 v34, v4, 12, v196
    v_add_u32 v34, s49, v34
    v_lshlrev_b32 v199, 4, v1
    s_lshl_b32 s48, s30, 10
    s_add_u32 s48, s48, s66
    s_add_u32 s49, s48, 0x8000
    v_add_u32 v15, s49, v199
    s_lshl_b32 s49, s28, 13
    s_add_u32 s94, s29, 3
    s_and_b32 s94, s94, 7
    s_lshl_b32 s94, s94, 12
    s_add_u32 s94, s94, s50
    s_add_u32 s94, s94, 98304
    s_add_u32 m0, s53, 143360
    v_add_u32 v213, s94, v33
    s_waitcnt vmcnt(4)
    global_load_lds_dwordx4 v213, s[6:7] nt
    s_add_u32 s49, s49, s48
    v_add_u32 v14, s49, v199
    s_lshl_b32 s59, s28, 6
    s_lshl_b32 s48, s28, 9
    s_lshl_b32 s49, s30, 6
    s_add_u32 s48, s48, s49
    s_add_u32 s49, s48, s66
    s_add_u32 s49, s49, 0xA000
    v_add_u32 v16, s49, v196
    s_add_u32 s49, s48, s67
    s_add_u32 s49, s49, 0x5000
    v_add_u32 v20, s49, v196
    s_add_u32 s94, s29, 4
    s_and_b32 s94, s94, 7
    s_lshl_b32 s94, s94, 12
    s_add_u32 s94, s94, s50
    s_add_u32 s94, s94, 131072
    s_add_u32 m0, s53, 122880
    v_add_u32 v213, s94, v33
    s_waitcnt vmcnt(4)
    global_load_lds_dwordx4 v213, s[6:7] nt
    v_mov_b32 v210, 1
    ds_write_b32 v211, v210
    v_lshlrev_b32 v195, 2, v1
    s_lshl_b32 s48, s30, 9
    s_add_u32 s48, s48, s67
    s_add_u32 s49, s48, 0x4000
    v_add_u32 v19, s49, v195
    s_lshl_b32 s49, s28, 12
    s_add_u32 s49, s49, s48
    v_add_u32 v17, s49, v195
    v_and_b32 v197, 1, v4
    v_lshrrev_b32 v194, 5, v1
    v_and_b32 v195, 31, v1
    v_lshlrev_b32 v195, 2, v195
    s_add_u32 s94, s29, 5
    s_and_b32 s94, s94, 7
    s_lshl_b32 s94, s94, 12
    s_add_u32 s94, s94, s50
    s_add_u32 s94, s94, 163840
    s_add_u32 m0, s53, 131072
    v_add_u32 v213, s94, v33
    s_waitcnt vmcnt(4)
    global_load_lds_dwordx4 v213, s[6:7] nt
    s_add_u32 s68, s24, 131072
    s_addc_u32 s69, s25, 0
    s_add_u32 s70, s24, 278528
    s_addc_u32 s71, s25, 0
    s_add_u32 s72, s24, 425984
    s_addc_u32 s73, s25, 0
    s_add_u32 s74, s24, 573440
    s_addc_u32 s75, s25, 0
    s_lshl_b32 s48, s61, 14
    s_lshl_b32 s49, s28, 11
    s_add_u32 s48, s48, s49
    s_lshl_b32 s49, s63, 10
    s_add_u32 s94, s29, 6
    s_and_b32 s94, s94, 7
    s_lshl_b32 s94, s94, 12
    s_add_u32 s94, s94, s50
    s_add_u32 s94, s94, 196608
    s_add_u32 m0, s53, 139264
    v_add_u32 v213, s94, v33
    s_waitcnt vmcnt(4)
    global_load_lds_dwordx4 v213, s[6:7] nt
    s_add_u32 s48, s48, s49
    v_add_u32 v12, s48, v199
    v_lshlrev_b32 v13, 7, v5
    v_add_u32 v13, 131072, v13
    s_lshl_b32 s54, s26, 8
    s_lshr_b32 s55, s27, 4
    s_lshl_b32 s48, s26, 11
    s_add_u32 s48, s48, 32768
    s_add_u32 s76, s24, s48
    s_addc_u32 s77, s25, 0
    v_lshlrev_b32 v50, 0, v195
    v_add_u32 v50, s48, v50
    s_add_u32 s94, s29, 7
    s_and_b32 s94, s94, 7
    s_lshl_b32 s94, s94, 12
    s_add_u32 s94, s94, s50
    s_add_u32 s94, s94, 229376
    s_add_u32 m0, s53, 147456
    v_add_u32 v213, s94, v33
    s_waitcnt vmcnt(4)
    global_load_lds_dwordx4 v213, s[6:7] nt
    s_lshl_b32 s49, s27, 2
    s_add_u32 s48, s48, s49
    v_mov_b32 v49, s48
    s_lshl_b32 s44, s26, 15
    s_lshl_b32 s49, s55, 14
    s_add_u32 s44, s44, s49
    s_add_u32 s44, s44, 1572864
    s_add_u32 s49, s44, s52
    v_lshlrev_b32 v192, 4, v1
    v_add_u32 v21, s49, v192
    s_lshl_b32 s45, s26, 10
    s_lshl_b32 s49, s55, 9
    s_add_u32 s94, s29, 0
    s_and_b32 s94, s94, 7
    s_lshl_b32 s94, s94, 12
    s_add_u32 s94, s94, s50
    s_add_u32 m0, s53, 16384
    v_add_u32 v213, s94, v32
    s_waitcnt vmcnt(4)
    global_load_lds_dwordx4 v213, s[8:9] nt
    s_add_u32 s45, s45, s49
    s_add_u32 s45, s45, 8192
    s_lshl_b32 s49, s61, 6
    s_add_u32 s49, s45, s49
    v_lshl_add_u32 v198, v4, 2, v5
    v_and_b32 v198, 7, v198
    v_lshlrev_b32 v198, 2, v198
    v_lshl_add_u32 v22, v194, 5, v198
    v_add_u32 v22, s49, v22
    s_mul_i32 s48, s61, 320
    s_lshl_b32 s49, s63, 7
    s_add_u32 s48, s48, s49
    s_add_u32 s94, s29, 1
    s_and_b32 s94, s94, 7
    s_lshl_b32 s94, s94, 12
    s_add_u32 s94, s94, s50
    s_add_u32 s94, s94, 32768
    s_add_u32 m0, s53, 24576
    v_add_u32 v213, s94, v32
    s_waitcnt vmcnt(4)
    global_load_lds_dwordx4 v213, s[8:9] nt
    s_add_u32 s48, s48, 153152
    v_lshlrev_b32 v25, 3, v5
    v_lshl_add_u32 v25, v4, 1, v25
    v_add_u32 v25, s48, v25
    v_add_u32 v28, 158528, v193
    s_movk_i32 s62, 80
    v_lshl_add_u32 v198, v194, 4, v5
    v_lshlrev_b32 v197, 2, v197
    v_mad_u32_u24 v26, v198, s62, v197
    s_lshl_b32 s48, s30, 3
    s_add_u32 s48, s48, 118784
    v_add_u32 v26, s48, v26
    s_add_u32 s94, s29, 2
    s_and_b32 s94, s94, 7
    s_lshl_b32 s94, s94, 12
    s_add_u32 s94, s94, s50
    s_add_u32 s94, s94, 65536
    s_add_u32 m0, s53, 32768
    v_add_u32 v213, s94, v32
    s_waitcnt vmcnt(4)
    global_load_lds_dwordx4 v213, s[8:9] nt
    v_lshlrev_b32 v198, 4, v3
    v_lshl_add_u32 v27, v197, 1, v198
    v_lshl_add_u32 v27, v2, 1, v27
    s_lshl_b32 s48, s30, 6
    s_add_u32 s48, s48, 123904
    v_add_u32 v27, s48, v27
    s_lshl_b32 s49, s55, 7
    s_add_u32 s49, s49, s54
    s_add_u32 s49, s49, 131072
    v_bfe_u32 v43, v1, 3, 2
    v_lshlrev_b32 v43, 11, v43
    v_lshl_add_u32 v43, v194, 13, v43
    s_add_u32 s94, s29, 3
    s_and_b32 s94, s94, 7
    s_lshl_b32 s94, s94, 12
    s_add_u32 s94, s94, s50
    s_add_u32 s94, s94, 98304
    s_add_u32 m0, s53, 40960
    v_add_u32 v213, s94, v32
    s_waitcnt vmcnt(4)
    global_load_lds_dwordx4 v213, s[8:9] nt
    v_and_b32 v46, 7, v1
    v_lshl_add_u32 v43, v46, 4, v43
    v_add_u32 v43, s49, v43
    s_xor_b32 s22, s30, 4
    s_or_b32 s22, s22, s60
    s_cselect_b32 s22, 0, 0x01010101
    s_mov_b32 s23, s22
    v_add_u32 v46, 154432, v192
    s_lshl_b32 s48, s51, 10
    s_add_u32 s48, s48, s44
    s_lshl_b32 s49, s60, 4
    s_add_u32 s48, s48, s49
    s_add_u32 s94, s29, 4
    s_and_b32 s94, s94, 7
    s_lshl_b32 s94, s94, 12
    s_add_u32 s94, s94, s50
    s_add_u32 s94, s94, 131072
    s_add_u32 m0, s53, 20480
    v_add_u32 v213, s94, v32
    s_waitcnt vmcnt(4)
    global_load_lds_dwordx4 v213, s[8:9] nt
    v_mov_b32 v210, 2
    ds_write_b32 v211, v210
    v_lshlrev_b32 v47, 12, v4
    v_lshl_add_u32 v47, v3, 8, v47
    v_lshl_add_u32 v47, v2, 2, v47
    v_add_u32 v47, s48, v47
    v_lshl_add_u32 v198, v4, 2, v3
    v_and_b32 v48, 7, v198
    s_lshl_b32 s48, s51, 1
    v_xor_b32 v48, s48, v48
    v_lshlrev_b32 v48, 5, v48
    v_lshl_add_u32 v48, v198, 8, v48
    v_lshl_add_u32 v48, v2, 3, v48
    s_lshr_b32 s48, s2, 6
    s_add_u32 s94, s29, 5
    s_and_b32 s94, s94, 7
    s_lshl_b32 s94, s94, 12
    s_add_u32 s94, s94, s50
    s_add_u32 s94, s94, 163840
    s_add_u32 m0, s53, 28672
    v_add_u32 v213, s94, v32
    s_waitcnt vmcnt(4)
    global_load_lds_dwordx4 v213, s[8:9] nt
    s_lshl_b32 s48, s48, 14
    s_and_b32 s49, s2, 63
    s_lshl_b32 s49, s49, 7
    s_add_u32 s48, s48, s49
    s_add_u32 s48, s48, 65536
    s_add_u32 s78, s24, s48
    s_addc_u32 s79, s25, 0
    s_mov_b32 s84, 0
    s_waitcnt lgkmcnt(0)
    s_add_u32 s31, s31, 991780647
    s_min_u32 s31, s31, -2
    s_and_b32 s32, s31, 0xff
    s_add_u32 s94, s29, 6
    s_and_b32 s94, s94, 7
    s_lshl_b32 s94, s94, 12
    s_add_u32 s94, s94, s50
    s_add_u32 s94, s94, 196608
    s_add_u32 m0, s53, 36864
    v_add_u32 v213, s94, v32
    s_waitcnt vmcnt(4)
    global_load_lds_dwordx4 v213, s[8:9] nt
    s_bfe_u32 s33, s31, 0x80008
    s_bfe_u32 s34, s31, 0x80010
    s_lshr_b32 s35, s31, 24
    v_lshlrev_b32 v168, 3, v2
    v_lshrrev_b32 v6, v168, s31
    v_and_b32 v6, 0xff, v6
    v_mov_b32 v8, s31
    s_mov_b32 s3, s31
    s_add_u32 s94, s29, 7
    s_and_b32 s94, s94, 7
    s_lshl_b32 s94, s94, 12
    s_add_u32 s94, s94, s50
    s_add_u32 s94, s94, 229376
    s_add_u32 m0, s53, 45056
    v_add_u32 v213, s94, v32
    s_waitcnt vmcnt(4)
    global_load_lds_dwordx4 v213, s[8:9] nt
    s_add_u32 s94, s91, 0
    s_and_b32 s94, s94, 3
    s_lshl_b32 s94, s94, 13
    s_add_u32 s94, s94, 0
    s_lshl_b32 s95, s94, 4
    s_add_u32 s94, s94, s53
    s_add_u32 m0, s94, 49152
    v_add_u32 v213, s95, v35
    s_waitcnt vmcnt(4)
    global_load_lds_dwordx4 v213, s[12:13]
    s_add_u32 s94, s91, 0
    s_and_b32 s94, s94, 3
    s_lshl_b32 s94, s94, 13
    s_add_u32 s94, s94, 4096
    s_lshl_b32 s95, s94, 4
    s_add_u32 s94, s94, s53
    s_add_u32 m0, s94, 49152
    v_add_u32 v213, s95, v35
    s_waitcnt vmcnt(4)
    global_load_lds_dwordx4 v213, s[12:13]
    s_add_u32 m0, s53, 81920
    v_add_u32 v213, 0, v36
    s_waitcnt vmcnt(4)
    global_load_lds_dwordx4 v213, s[16:17]
    s_add_u32 m0, s53, 86016
    v_add_u32 v213, 229376, v36
    s_waitcnt vmcnt(4)
    global_load_lds_dwordx4 v213, s[16:17]
    s_waitcnt vmcnt(4)
    v_mov_b32 v210, 3
    ds_write_b32 v211, v210
    s_add_u32 s94, s91, 1
    s_and_b32 s94, s94, 3
    s_lshl_b32 s94, s94, 13
    s_add_u32 s94, s94, 0
    s_lshl_b32 s95, s94, 4
    s_add_u32 s94, s94, s53
    s_add_u32 m0, s94, 49152
    v_add_u32 v213, s95, v35
    global_load_lds_dwordx4 v213, s[12:13]
    s_add_u32 s94, s91, 1
    s_and_b32 s94, s94, 3
    s_lshl_b32 s94, s94, 13
    s_add_u32 s94, s94, 4096
    s_lshl_b32 s95, s94, 4
    s_add_u32 s94, s94, s53
    s_add_u32 m0, s94, 49152
    v_add_u32 v213, s95, v35
    global_load_lds_dwordx4 v213, s[12:13]
    s_add_u32 s94, s91, 2
    s_and_b32 s94, s94, 3
    s_lshl_b32 s94, s94, 13
    s_add_u32 s94, s94, 0
    s_lshl_b32 s95, s94, 4
    s_add_u32 s94, s94, s53
    s_add_u32 m0, s94, 49152
    v_add_u32 v213, s95, v35
    global_load_lds_dwordx4 v213, s[12:13]
    s_add_u32 s94, s91, 2
    s_and_b32 s94, s94, 3
    s_lshl_b32 s94, s94, 13
    s_add_u32 s94, s94, 4096
    s_lshl_b32 s95, s94, 4
    s_add_u32 s94, s94, s53
    s_add_u32 m0, s94, 49152
    v_add_u32 v213, s95, v35
    global_load_lds_dwordx4 v213, s[12:13]
    s_add_u32 s94, s91, 3
    s_and_b32 s94, s94, 3
    s_lshl_b32 s94, s94, 13
    s_add_u32 s94, s94, 0
    s_lshl_b32 s95, s94, 4
    s_add_u32 s94, s94, s53
    s_add_u32 m0, s94, 49152
    v_add_u32 v213, s95, v35
    global_load_lds_dwordx4 v213, s[12:13]
    s_add_u32 s94, s91, 3
    s_and_b32 s94, s94, 3
    s_lshl_b32 s94, s94, 13
    s_add_u32 s94, s94, 4096
    s_lshl_b32 s95, s94, 4
    s_add_u32 s94, s94, s53
    s_add_u32 m0, s94, 49152
    v_add_u32 v213, s95, v35
    global_load_lds_dwordx4 v213, s[12:13]
    global_load_dword v166, v59, s[4:5]
    s_waitcnt vmcnt(0)
    v_lshlrev_b32 v54, 16, v166
    v_and_b32 v55, 0xffff0000, v166
    s_lshr_b32 s48, s26, 2
    s_xor_b32 s48, s48, 0
    s_lshl_b32 s88, s48, 13
    v_add_u32 v12, s88, v12
    v_add_u32 v13, s88, v13
    s_setprio 1
    s_waitcnt vmcnt(0)
    s_barrier
    s_mov_b32 s46, 0
    global_load_dword v160, v22, s[24:25] sc1
    global_load_dword v165, v22, s[24:25] offset:256 sc1
    global_load_dwordx4 v[152:155], v21, s[24:25] sc1
    global_load_dwordx4 v[156:159], v21, s[24:25] offset:1024 sc1
    s_nop 15
    s_nop 15
    s_nop 15
    s_nop 15
    s_nop 5
    s_add_u32 s94, s51, 0
    s_min_u32 s94, s94, 6
    s_mul_i32 s95, s28, 7
    s_add_u32 s94, s94, s95
    s_lshl_b32 s95, s94, 13
    s_lshl_b32 s94, s94, 10
    s_add_u32 m0, s94, 90112
    v_add_u32 v213, s95, v29
    global_load_lds_dwordx4 v213, s[18:19]
    s_add_u32 s94, s51, 4
    s_min_u32 s94, s94, 6
    s_mul_i32 s95, s28, 7
    s_add_u32 s94, s94, s95
    s_lshl_b32 s95, s94, 13
    s_lshl_b32 s94, s94, 10
    s_add_u32 m0, s94, 90112
    v_add_u32 v213, s95, v29
    global_load_lds_dwordx4 v213, s[18:19]
    v_and_b32 v192, 1, v3
    v_lshlrev_b32 v192, 4, v192
    v_lshl_add_u32 v192, v4, 2, v192
    v_lshrrev_b32 v193, 1, v3
    v_add_u32 v192, v192, v193
    v_and_b32 v193, 1, v4
    v_lshlrev_b32 v193, 5, v193
    v_lshl_add_u32 v193, v192, 6, v193
    v_lshl_add_u32 v193, v2, 3, v193
    s_lshl_b32 s48, s30, 12
    s_add_u32 s48, s48, 49152
    v_add_u32 v193, s48, v193
    v_xor_b32 v194, 32, v193
    ds_read_b64_tr_b16 v[136:137], v193 offset:0
    ds_read_b64_tr_b16 v[138:139], v193 offset:128
    ds_read_b64_tr_b16 v[140:141], v193 offset:2048
    ds_read_b64_tr_b16 v[142:143], v193 offset:2176
    ds_read_b64_tr_b16 v[144:145], v194 offset:0
    ds_read_b64_tr_b16 v[146:147], v194 offset:128
    ds_read_b64_tr_b16 v[148:149], v194 offset:2048
    ds_read_b64_tr_b16 v[150:151], v194 offset:2176
    s_waitcnt lgkmcnt(0)
Lp_128:
    s_waitcnt vmcnt(4)
    v_max_f32_dpp v161, v160, v160 row_ror:1 row_mask:0xf bank_mask:0xf
    v_max_u32 v166, v160, v165
    s_nop 0
    v_max_f32_dpp v161, v161, v161 row_ror:2 row_mask:0xf bank_mask:0xf
    s_waitcnt vmcnt(3)
    v_mfma_f32_16x16x32_bf16 v[168:171], v[152:155], v[136:139], 0
    v_max_f32_dpp v161, v161, v161 row_ror:4 row_mask:0xf bank_mask:0xf
    v_sub_f32 v164, v160, v161
    v_mfma_f32_16x16x32_bf16 v[172:175], v[152:155], v[144:147], 0
    v_exp_f32 v164, v164
    s_waitcnt vmcnt(2)
    v_mfma_f32_16x16x32_bf16 v[168:171], v[156:159], v[140:143], v[168:171]
    v_mul_f32 v161, v164, v165
    v_max3_u32 v162, v152, v153, v154
    v_mfma_f32_16x16x32_bf16 v[172:175], v[156:159], v[148:151], v[172:175]
    v_add_f32_dpp v161, v161, v161 row_ror:1 row_mask:0xf bank_mask:0xf
    v_max3_u32 v163, v155, v156, v157
    v_max3_u32 v162, v162, v158, v159
    v_add_f32_dpp v161, v161, v161 row_ror:2 row_mask:0xf bank_mask:0xf
    v_max3_u32 v162, v162, v163, v166
    v_cmp_eq_u32 vcc, -1, v162
    v_add_f32_dpp v161, v161, v161 row_ror:4 row_mask:0xf bank_mask:0xf
    v_mul_f32_dpp v162, v164, v168 row_newbcast:0 row_mask:0xf bank_mask:0xf
    v_rcp_f32 v161, v161
    s_cbranch_vccnz Lr_129
Ld_130:
    s_mov_b64 exec, s[22:23]
    s_cbranch_execz Lh_131
    global_store_dword v43, v8, s[68:69] sc1
Lh_131:
    s_mov_b64 exec, -1
    v_fmac_f32_dpp v162, v164, v169 row_newbcast:1 row_mask:0xf bank_mask:0xf
    v_fmac_f32_dpp v162, v164, v170 row_newbcast:2 row_mask:0xf bank_mask:0xf
    v_fmac_f32_dpp v162, v164, v171 row_newbcast:3 row_mask:0xf bank_mask:0xf
    v_mul_f32_dpp v163, v164, v172 row_newbcast:0 row_mask:0xf bank_mask:0xf
    v_mul_f32 v162, v162, v161
    v_fmac_f32_dpp v163, v164, v173 row_newbcast:1 row_mask:0xf bank_mask:0xf
    ds_write_b32 v26, v162
    v_fmac_f32_dpp v163, v164, v174 row_newbcast:2 row_mask:0xf bank_mask:0xf
    v_fmac_f32_dpp v163, v164, v175 row_newbcast:3 row_mask:0xf bank_mask:0xf
    v_mul_f32 v163, v163, v161
    ds_write_b32 v26, v163 offset:2560
    s_cmp_eq_u32 s30, 7
    s_cbranch_scc0 Lk_133
    s_waitcnt lgkmcnt(0)
    s_barrier
    s_nop 15
    s_nop 15
    s_nop 15
    s_nop 11
    v_add_u32 v21, 262144, v21
    v_add_u32 v22, 8192, v22
    v_add_u32 v47, 262144, v47
    v_xor_b32 v212, 32, v48
    ds_read_b64_tr_b16 v[60:61], v48 offset:16384
    ds_read_b64_tr_b16 v[62:63], v48 offset:20480
    ds_read_b64_tr_b16 v[76:77], v212 offset:16384
    ds_read_b64_tr_b16 v[78:79], v212 offset:20480
    ds_read_b64_tr_b16 v[64:65], v48 offset:24576
    ds_read_b64_tr_b16 v[66:67], v48 offset:28672
    ds_read_b64_tr_b16 v[80:81], v212 offset:24576
    ds_read_b64_tr_b16 v[82:83], v212 offset:28672
    ds_read_b64_tr_b16 v[68:69], v48 offset:32768
    ds_read_b64_tr_b16 v[70:71], v48 offset:36864
    ds_read_b64_tr_b16 v[84:85], v212 offset:32768
    ds_read_b64_tr_b16 v[86:87], v212 offset:36864
    ds_read_b64_tr_b16 v[72:73], v48 offset:40960
    ds_read_b64_tr_b16 v[74:75], v48 offset:45056
    ds_read_b64_tr_b16 v[88:89], v212 offset:40960
    ds_read_b64_tr_b16 v[90:91], v212 offset:45056
    v_lshl_add_u32 v192, v4, 2, v3
    v_and_b32 v193, 1, v4
    v_xor_b32 v193, s63, v193
    v_lshlrev_b32 v193, 5, v193
    v_lshl_add_u32 v193, v192, 6, v193
    v_lshl_add_u32 v193, v2, 3, v193
    v_add_u32 v193, 81920, v193
    ds_read_b64_tr_b16 v[92:93], v193 offset:0
    ds_read_b64_tr_b16 v[94:95], v193 offset:1024
    ds_read_b64_tr_b16 v[96:97], v193 offset:2048
    ds_read_b64_tr_b16 v[98:99], v193 offset:3072
    ds_read_b64_tr_b16 v[100:101], v193 offset:4096
    ds_read_b64_tr_b16 v[102:103], v193 offset:5120
    ds_read_b64_tr_b16 v[104:105], v193 offset:6144
    ds_read_b64_tr_b16 v[106:107], v193 offset:7168
    v_mov_b32 v211, 158880
    ds_read_b128 v[204:207], v211
    s_lshl_b32 s48, s51, 8
    s_add_u32 s48, s48, 158912
    v_lshlrev_b32 v211, 2, v1
    v_add_u32 v211, s48, v211
    ds_read_b32 v56, v211
    s_waitcnt lgkmcnt(0)
    v_and_b32 v204, v204, v205
    v_and_b32 v206, v206, v207
    v_and_b32 v204, v204, v206
    s_nop 0
    v_readfirstlane_b32 s37, v204
    s_nop 0
    s_cmp_eq_u32 s37, 0
    s_cselect_b64 s[38:39], s[40:41], s[24:25]
    v_mov_b32 v153, 158896
    s_mov_b32 s46, 0
Lq_134:
    ds_read_b32 v152, v153
    s_add_u32 s46, s46, 1
    s_cmp_gt_u32 s46, 0x10000
    s_cbranch_scc1 Lq_135
    s_waitcnt lgkmcnt(0)
    v_cmp_eq_u32 vcc, 0, v152
    s_cbranch_vccnz Lq_134
Lq_135:
    s_waitcnt lgkmcnt(0)
    s_movk_i32 s48, 0x2000
    v_bfi_b32 v12, s48, v152, v12
    v_bfi_b32 v13, s48, v152, v13
    s_barrier
    s_mov_b64 exec, -1
    s_branch Lj_132
L_pad12:
    s_branch L_pad16
Lk_133:
    s_waitcnt lgkmcnt(0)
    s_barrier
    s_nop 15
    s_nop 15
    s_nop 15
    s_nop 11
    s_add_u32 s48, s28, s51
    s_add_u32 s48, s48, 1
    s_and_b32 s48, s48, 3
    s_mul_i32 s48, s48, 7
    s_lshl_b32 s49, s48, 13
    v_add_u32 v213, s49, v29
    s_lshl_b32 s48, s48, 10
    s_add_u32 m0, s48, 90112
    s_nop 0
    global_load_lds_dwordx4 v213, s[18:19]
    v_add_u32 v213, 0x2000, v213
    s_add_u32 m0, s48, 91136
    s_nop 0
    global_load_lds_dwordx4 v213, s[18:19]
    v_add_u32 v213, 0x2000, v213
    s_add_u32 m0, s48, 92160
    s_nop 0
    global_load_lds_dwordx4 v213, s[18:19]
    v_add_u32 v213, 0x2000, v213
    s_add_u32 m0, s48, 93184
    s_nop 0
    global_load_lds_dwordx4 v213, s[18:19]
    v_add_u32 v213, 0x2000, v213
    s_add_u32 m0, s48, 94208
    s_nop 0
    global_load_lds_dwordx4 v213, s[18:19]
    v_add_u32 v213, 0x2000, v213
    s_add_u32 m0, s48, 95232
    s_nop 0
    global_load_lds_dwordx4 v213, s[18:19]
    v_add_u32 v213, 0x2000, v213
    s_add_u32 m0, s48, 96256
    s_nop 0
    global_load_lds_dwordx4 v213, s[18:19]
    v_add_u32 v21, 262144, v21
    v_add_u32 v22, 8192, v22
    v_add_u32 v47, 262144, v47
    v_xor_b32 v212, 32, v48
    ds_read_b64_tr_b16 v[60:61], v48 offset:16384
    ds_read_b64_tr_b16 v[62:63], v48 offset:20480
    ds_read_b64_tr_b16 v[76:77], v212 offset:16384
    ds_read_b64_tr_b16 v[78:79], v212 offset:20480
    ds_read_b64_tr_b16 v[64:65], v48 offset:24576
    ds_read_b64_tr_b16 v[66:67], v48 offset:28672
    ds_read_b64_tr_b16 v[80:81], v212 offset:24576
    ds_read_b64_tr_b16 v[82:83], v212 offset:28672
    ds_read_b64_tr_b16 v[68:69], v48 offset:32768
    ds_read_b64_tr_b16 v[70:71], v48 offset:36864
    ds_read_b64_tr_b16 v[84:85], v212 offset:32768
    ds_read_b64_tr_b16 v[86:87], v212 offset:36864
    ds_read_b64_tr_b16 v[72:73], v48 offset:40960
    ds_read_b64_tr_b16 v[74:75], v48 offset:45056
    ds_read_b64_tr_b16 v[88:89], v212 offset:40960
    ds_read_b64_tr_b16 v[90:91], v212 offset:45056
    v_lshl_add_u32 v192, v4, 2, v3
    v_and_b32 v193, 1, v4
    v_xor_b32 v193, s63, v193
    v_lshlrev_b32 v193, 5, v193
    v_lshl_add_u32 v193, v192, 6, v193
    v_lshl_add_u32 v193, v2, 3, v193
    v_add_u32 v193, 81920, v193
    ds_read_b64_tr_b16 v[92:93], v193 offset:0
    ds_read_b64_tr_b16 v[94:95], v193 offset:1024
    ds_read_b64_tr_b16 v[96:97], v193 offset:2048
    ds_read_b64_tr_b16 v[98:99], v193 offset:3072
    ds_read_b64_tr_b16 v[100:101], v193 offset:4096
    ds_read_b64_tr_b16 v[102:103], v193 offset:5120
    ds_read_b64_tr_b16 v[104:105], v193 offset:6144
    ds_read_b64_tr_b16 v[106:107], v193 offset:7168
    v_mov_b32 v211, 158880
    ds_read_b128 v[204:207], v211
    s_lshl_b32 s48, s51, 8
    s_add_u32 s48, s48, 158912
    v_lshlrev_b32 v211, 2, v1
    v_add_u32 v211, s48, v211
    ds_read_b32 v56, v211
    s_waitcnt lgkmcnt(0)
    v_and_b32 v204, v204, v205
    v_and_b32 v206, v206, v207
    v_and_b32 v204, v204, v206
    s_nop 0
    v_readfirstlane_b32 s37, v204
    s_nop 0
    s_cmp_eq_u32 s37, 0
    s_cselect_b64 s[38:39], s[40:41], s[24:25]
    v_mov_b32 v153, 158896
    s_mov_b32 s46, 0
Lq_136:
    ds_read_b32 v152, v153
    s_add_u32 s46, s46, 1
    s_cmp_gt_u32 s46, 0x10000
    s_cbranch_scc1 Lq_137
    s_waitcnt lgkmcnt(0)
    v_cmp_eq_u32 vcc, 0, v152
    s_cbranch_vccnz Lq_136
Lq_137:
    s_waitcnt lgkmcnt(0)
    s_movk_i32 s48, 0x2000
    v_bfi_b32 v12, s48, v152, v12
    v_bfi_b32 v13, s48, v152, v13
    s_barrier
Lj_132:
    s_mov_b32 s46, 0
    global_load_dwordx4 v[152:155], v12, s[68:69] sc1
    s_waitcnt vmcnt(0)
Lp_138:
    v_lshlrev_b32 v156, 16, v152
    v_and_b32 v157, 0xffff0000, v152
    v_lshlrev_b32 v160, 16, v154
    v_and_b32 v161, 0xffff0000, v154
    v_lshlrev_b32 v158, 16, v153
    v_and_b32 v159, 0xffff0000, v153
    v_lshlrev_b32 v162, 16, v155
    v_and_b32 v163, 0xffff0000, v155
    v_permlane32_swap_b32 v156, v160
    v_permlane32_swap_b32 v157, v161
    v_permlane32_swap_b32 v158, v162
    v_permlane32_swap_b32 v159, v163
    v_pk_add_f32 v[156:157], v[156:157], v[160:161]
    v_pk_add_f32 v[158:159], v[158:159], v[162:163]
    v_max3_u32 v152, v152, v153, v154
    s_nop 0
    v_permlane16_swap_b32 v156, v158
    v_permlane16_swap_b32 v157, v159
    v_pk_add_f32 v[156:157], v[156:157], v[158:159]
    v_max_u32 v152, v152, v155
    v_cmp_eq_u32 vcc, -1, v152
    v_add_f32_dpp v158, v156, v156 row_ror:8 row_mask:0xf bank_mask:0xf
    v_add_f32_dpp v159, v157, v157 row_ror:8 row_mask:0xf bank_mask:0xf
    v_pk_add_f32 v[158:159], v[158:159], v[54:55]
    v_cvt_pk_bf16_f32 v166, v158, v159
    s_cbranch_vccnz Lr_139
Ld_140:
    ds_write_b32 v23, v166
    v_lshlrev_b32 v54, 16, v166
    v_and_b32 v55, 0xffff0000, v166
    s_lshr_b32 s48, s30, 1
    s_sub_u32 s48, s48, 2
    s_or_b32 s48, s48, s92
    s_cmp_eq_u32 s48, 0
    s_cbranch_scc0 Lk_142
    s_waitcnt lgkmcnt(0)
    s_barrier
    ds_read_b128 v[168:171], v24 offset:0
    ds_read_b128 v[172:175], v24 offset:64
    ds_read_b128 v[176:179], v24 offset:128
    ds_read_b128 v[180:183], v24 offset:192
    s_waitcnt lgkmcnt(3)
    v_mfma_f32_16x16x32_bf16 v[184:187], v[168:171], v[92:95], 0
    s_waitcnt lgkmcnt(2)
    v_mfma_f32_16x16x32_bf16 v[184:187], v[172:175], v[96:99], v[184:187]
    s_waitcnt lgkmcnt(1)
    v_mfma_f32_16x16x32_bf16 v[184:187], v[176:179], v[100:103], v[184:187]
    s_waitcnt lgkmcnt(0)
    v_mfma_f32_16x16x32_bf16 v[184:187], v[180:183], v[104:107], v[184:187]
    v_add_u32 v188, 16384, v34
    s_cmp_eq_u32 s37, 0
    s_nop 5
    v_and_or_b32 v184, v184, s36, v6
    v_and_or_b32 v185, v185, s36, v6
    s_cbranch_scc1 Ls_143
    global_store_dword v34, v184, s[24:25]
    s_mov_b64 exec, 0xffff
    global_store_dword v188, v185, s[24:25]
    s_mov_b64 exec, -1
Ls_144:
    s_barrier
    s_mov_b64 exec, -1
    s_branch Lj_141
L_pad13:
    s_branch L_pad17
Lk_142:
    s_waitcnt lgkmcnt(0)
    s_barrier
    s_barrier
Lj_141:
    s_cmp_ge_u32 s30, 7
    s_cbranch_scc1 Le_146
    s_mov_b32 s46, 0
    global_load_dword v162, v20, s[24:25] sc1
    global_load_dword v152, v17, s[24:25] sc1
    global_load_dword v153, v17, s[24:25] offset:256 sc1
    global_load_dword v154, v19, s[24:25] sc1
    global_load_dword v155, v19, s[24:25] offset:256 sc1
    v_mov_b32 v164, 0x3b000000
    s_waitcnt vmcnt(0)
Lp_147:
    v_xor_b32 v162, v6, v162
    v_xor_b32 v152, v6, v152
    v_xor_b32 v153, v6, v153
    v_add_f32_dpp v163, v162, v162 row_ror:4 row_mask:0xf bank_mask:0xf
    v_add_f32 v156, v152, v153
    v_add_f32 v157, v152, v153
    v_add_f32_dpp v163, v163, v163 row_ror:8 row_mask:0xf bank_mask:0xf
    v_or3_b32 v160, v152, v153, v162
    v_permlane32_swap_b32 v156, v157
    v_xor_b32 v154, v6, v154
    v_xor_b32 v155, v6, v155
    v_add_f32 v158, v154, v155
    v_add_f32 v159, v154, v155
    v_or3_b32 v160, v160, v154, v155
    s_nop 0
    v_permlane32_swap_b32 v158, v159
    v_add_f32 v57, v158, v159
    v_mul_f32_dpp v165, v163, v164 row_newbcast:1 row_mask:0xf bank_mask:0xf
    v_mul_f32_dpp v164, v163, v164 row_newbcast:0 row_mask:0xf bank_mask:0xf
    v_cmp_ne_u32_sdwa vcc, v160, v7 src0_sel:BYTE_0 src1_sel:DWORD
    v_fma_f32 v164, -v165, v165, v164
    v_add_f32 v152, v156, v157
    v_max_f32 v164, 0, v164
    v_add_f32 v164, 0x3727c5ac, v164
    v_rsq_f32 v164, v164
    v_fma_f32 v152, -v165, v57, v152
    s_cbranch_vccnz Lr_148
Ld_149:
    s_mov_b64 exec, s[22:23]
    s_cbranch_execz Lh_150
    global_store_dword v43, v8, s[70:71] sc1
Lh_150:
    s_mov_b64 exec, -1
    v_mul_f32 v152, v152, v164
    v_mul_f32 v153, 0xbfb8aa3b, v152
    v_exp_f32 v153, v153
    s_nop 0
    v_add_f32 v153, 1.0, v153
    v_rcp_f32 v153, v153
    s_nop 0
    v_mul_f32 v152, v152, v153
    v_cvt_pk_bf16_f32 v152, v152, v152
    ds_write_b16 v27, v152
Le_145:
    s_cmp_eq_u32 s30, 7
    s_cbranch_scc0 Lk_152
    s_mov_b32 s46, 0
    s_mov_b64 exec, 0xffff
    v_add_u32 v182, 4096, v13
    s_waitcnt lgkmcnt(0)
    s_barrier
    s_nop 15
    s_nop 15
    s_nop 7
    global_load_dword v9, v13, s[70:71] offset:0 sc1
    s_nop 15
    s_nop 15
    s_nop 2
    global_load_dword v18, v13, s[70:71] offset:2048 sc1
    s_waitcnt vmcnt(1)
    v_cmp_ne_u32 vcc, s31, v9
    s_cbranch_vccz Ld_154
    s_add_u32 s46, s46, 1
    global_load_dword v9, v182, s[70:71] offset:0 sc1
    s_waitcnt vmcnt(1)
    v_cmp_ne_u32 vcc, s31, v18
    s_cbranch_vccz Ld_154
    s_add_u32 s46, s46, 1
    global_load_dword v18, v182, s[70:71] offset:2048 sc1
Lp_153:
    s_waitcnt vmcnt(1)
    v_cmp_ne_u32 vcc, s31, v9
    s_cbranch_vccz Ld_154
    s_add_u32 s46, s46, 1
    global_load_dword v9, v182, s[70:71] offset:2048 sc1
    s_waitcnt vmcnt(1)
    v_cmp_ne_u32 vcc, s31, v18
    s_cbranch_vccz Ld_154
    s_add_u32 s46, s46, 1
    global_load_dword v18, v182, s[70:71] offset:2048 sc1
    s_cmp_lt_u32 s46, 0x8000
    s_cbranch_scc1 Lp_153
Ld_154:
    s_barrier
    s_mov_b64 exec, -1
    v_mov_b32 v153, 158900
    s_mov_b32 s46, 0
Lq_155:
    ds_read_b32 v152, v153
    s_add_u32 s46, s46, 1
    s_cmp_gt_u32 s46, 0x10000
    s_cbranch_scc1 Lq_156
    s_waitcnt lgkmcnt(0)
    v_cmp_eq_u32 vcc, 0, v152
    s_cbranch_vccnz Lq_155
Lq_156:
    s_waitcnt lgkmcnt(0)
    s_movk_i32 s48, 0x2000
    v_bfi_b32 v12, s48, v152, v12
    v_bfi_b32 v13, s48, v152, v13
    s_branch Lj_151
L_pad15:
    s_branch L_pad19
Lk_152:
    s_cmp_eq_u32 s30, 6
    s_cbranch_scc0 Lk_157
    s_waitcnt lgkmcnt(0)
    s_barrier
    v_mov_b32 v153, 158896
    ds_read_b32 v154, v153 offset:8
    s_waitcnt lgkmcnt(0)
    v_readfirstlane_b32 s84, v154
    s_memtime s[80:81]
    s_waitcnt lgkmcnt(0)
    s_load_dword s86, s[78:79], 8192 glc
    s_waitcnt lgkmcnt(0)
    s_memtime s[82:83]
    s_waitcnt lgkmcnt(0)
    s_sub_u32 s85, s82, s80
    s_min_u32 s84, s84, 520
    s_cmp_lt_u32 s85, s84
    s_cselect_b32 s48, 0x2001, 1
    v_mov_b32 v152, s48
    ds_write_b32 v153, v152 offset:4
    v_mov_b32 v153, 158900
    s_mov_b32 s46, 0
Lq_158:
    ds_read_b32 v152, v153
    s_add_u32 s46, s46, 1
    s_cmp_gt_u32 s46, 0x10000
    s_cbranch_scc1 Lq_159
    s_waitcnt lgkmcnt(0)
    v_cmp_eq_u32 vcc, 0, v152
    s_cbranch_vccnz Lq_158
Lq_159:
    s_waitcnt lgkmcnt(0)
    s_movk_i32 s48, 0x2000
    v_bfi_b32 v12, s48, v152, v12
    v_bfi_b32 v13, s48, v152, v13
    s_barrier
    s_mov_b64 exec, -1
    s_branch Lj_151
L_pad16:
    s_branch L_pad20
Lk_157:
    s_waitcnt lgkmcnt(0)
    s_barrier
    v_mov_b32 v153, 158900
    s_mov_b32 s46, 0
Lq_160:
    ds_read_b32 v152, v153
    s_add_u32 s46, s46, 1
    s_cmp_gt_u32 s46, 0x10000
    s_cbranch_scc1 Lq_161
    s_waitcnt lgkmcnt(0)
    v_cmp_eq_u32 vcc, 0, v152
    s_cbranch_vccnz Lq_160
Lq_161:
    s_waitcnt lgkmcnt(0)
    s_movk_i32 s48, 0x2000
    v_bfi_b32 v12, s48, v152, v12
    v_bfi_b32 v13, s48, v152, v13
    s_barrier
Lj_151:
    s_mov_b32 s46, 0
    global_load_dwordx4 v[152:155], v12, s[70:71] sc1
    s_waitcnt vmcnt(0)
Lp_162:
    v_lshlrev_b32 v156, 16, v152
    v_and_b32 v157, 0xffff0000, v152
    v_lshlrev_b32 v160, 16, v154
    v_and_b32 v161, 0xffff0000, v154
    v_lshlrev_b32 v158, 16, v153
    v_and_b32 v159, 0xffff0000, v153
    v_lshlrev_b32 v162, 16, v155
    v_and_b32 v163, 0xffff0000, v155
    v_permlane32_swap_b32 v156, v160
    v_permlane32_swap_b32 v157, v161
    v_permlane32_swap_b32 v158, v162
    v_permlane32_swap_b32 v159, v163
    v_pk_add_f32 v[156:157], v[156:157], v[160:161]
    v_pk_add_f32 v[158:159], v[158:159], v[162:163]
    v_max3_u32 v152, v152, v153, v154
    s_nop 0
    v_permlane16_swap_b32 v156, v158
    v_permlane16_swap_b32 v157, v159
    v_pk_add_f32 v[156:157], v[156:157], v[158:159]
    v_max_u32 v152, v152, v155
    v_cmp_eq_u32 vcc, -1, v152
    v_add_f32_dpp v158, v156, v156 row_ror:8 row_mask:0xf bank_mask:0xf
    v_add_f32_dpp v159, v157, v157 row_ror:8 row_mask:0xf bank_mask:0xf
    v_pk_add_f32 v[158:159], v[158:159], v[54:55]
    v_cvt_pk_bf16_f32 v166, v158, v159
    s_cbranch_vccnz Lr_163
Ld_164:
    ds_write_b32 v23, v166
    v_lshlrev_b32 v54, 16, v166
    v_and_b32 v55, 0xffff0000, v166
    s_add_u32 s31, s31, 991780647
    s_min_u32 s31, s31, -2
    s_and_b32 s32, s31, 0xff
    s_bfe_u32 s33, s31, 0x80008
    s_bfe_u32 s34, s31, 0x80010
    s_lshr_b32 s35, s31, 24
    v_lshlrev_b32 v168, 3, v2
    v_lshrrev_b32 v6, v168, s31
    v_and_b32 v6, 0xff, v6
    v_mov_b32 v8, s31
    s_cmp_eq_u32 s30, 7
    s_cbranch_scc0 Lk_166
    s_waitcnt lgkmcnt(0)
    s_barrier
    ds_read_b128 v[168:171], v24 offset:0
    ds_read_b128 v[172:175], v24 offset:64
    ds_read_b128 v[176:179], v24 offset:128
    ds_read_b128 v[180:183], v24 offset:192
    s_lshl_b32 s48, s47, 8
    s_or_b32 s48, s48, s34
    s_waitcnt lgkmcnt(3)
    v_mfma_f32_16x16x32_bf16 v[184:187], v[168:171], v[168:171], 0
    s_waitcnt lgkmcnt(2)
    v_mfma_f32_16x16x32_bf16 v[184:187], v[172:175], v[172:175], v[184:187]
    s_waitcnt lgkmcnt(1)
    v_mfma_f32_16x16x32_bf16 v[184:187], v[176:179], v[176:179], v[184:187]
    s_waitcnt lgkmcnt(0)
    v_mfma_f32_16x16x32_bf16 v[184:187], v[180:183], v[180:183], v[184:187]
    v_mov_b32 v188, s32
    v_mov_b32 v189, s33
    v_mov_b32 v190, s48
    v_mov_b32 v191, s35
    s_mov_b64 exec, s[14:15]
    s_cmp_eq_u32 s37, 0
    s_nop 1
    v_and_or_b32 v188, v184, s36, v188
    v_and_or_b32 v189, v185, s36, v189
    s_cbranch_scc1 Ls_167
    global_store_dwordx4 v45, v[188:191], s[38:39]
Ls_168:
    s_mov_b64 exec, -1
    s_barrier
    s_mov_b64 exec, -1
    s_branch Lj_165
L_pad17:
    s_branch L_pad21
Lk_166:
    s_cmp_eq_u32 s30, 6
    s_cbranch_scc0 Lk_169
    s_add_u32 s49, s3, 3
    v_mov_b32 v9, s49
    s_mov_b32 s42, -1
    s_mov_b32 s43, 0
    s_mov_b64 exec, 1
    s_cmp_eq_u32 s37, 0
    s_waitcnt lgkmcnt(0)
    s_barrier
    s_cbranch_scc1 Ls_170
    global_store_dword v49, v9, s[24:25]
Ls_171:
    s_mov_b64 exec, s[42:43]
    s_nop 15
    s_nop 3
    s_mov_b32 s46, 0
    global_load_dword v9, v50, s[24:25] sc1
    s_nop 13
    global_load_dword v18, v50, s[24:25] sc1
    s_nop 13
    global_load_dword v51, v50, s[24:25] sc1
    s_nop 13
    global_load_dword v52, v50, s[24:25] sc1
Lp_172:
    s_waitcnt vmcnt(3)
    v_subrev_u32 v9, s49, v9
    v_cmp_le_u32 vcc, 8, v9
    s_cbranch_vccz Ld_173
    global_load_dword v9, v50, s[24:25] sc1
    s_add_u32 s46, s46, 1
    s_waitcnt vmcnt(3)
    v_subrev_u32 v18, s49, v18
    v_cmp_le_u32 vcc, 8, v18
    s_cbranch_vccz Ld_173
    global_load_dword v18, v50, s[24:25] sc1
    s_add_u32 s46, s46, 1
    s_waitcnt vmcnt(3)
    v_subrev_u32 v51, s49, v51
    v_cmp_le_u32 vcc, 8, v51
    s_cbranch_vccz Ld_173
    global_load_dword v51, v50, s[24:25] sc1
    s_add_u32 s46, s46, 1
    s_waitcnt vmcnt(3)
    v_subrev_u32 v52, s49, v52
    v_cmp_le_u32 vcc, 8, v52
    s_cbranch_vccz Ld_173
    global_load_dword v52, v50, s[24:25] sc1
    s_add_u32 s46, s46, 1
    s_cmp_lt_u32 s46, 0x10000
    s_cbranch_scc1 Lp_172
Ld_173:
    s_barrier
    s_mov_b64 exec, -1
    s_branch Lj_165
L_pad18:
    s_setpc_b64 s[94:95]
Lk_169:
    s_waitcnt lgkmcnt(0)
    s_barrier
    s_barrier
Lj_165:
    s_mov_b32 s46, 0
    global_load_dword v162, v16, s[38:39] sc1
    global_load_dwordx4 v[152:155], v14, s[38:39] sc1
    v_mov_b32 v164, 0x3b000000
    s_waitcnt vmcnt(0)
Lp_174:
    v_xor_b32 v162, v6, v162
    v_xor_b32 v152, s32, v152
    v_xor_b32 v153, s33, v153
    v_xor_b32 v154, s34, v154
    v_xor_b32 v155, s35, v155
    v_add_f32_dpp v163, v162, v162 row_ror:4 row_mask:0xf bank_mask:0xf
    v_or3_b32 v160, v152, v153, v154
    v_or3_b32 v160, v160, v155, v162
    v_add_f32_dpp v163, v163, v163 row_ror:8 row_mask:0xf bank_mask:0xf
    v_permlane32_swap_b32 v152, v154
    v_permlane32_swap_b32 v153, v155
    v_pk_add_f32 v[152:153], v[152:153], v[154:155]
    v_cmp_ne_u32_sdwa vcc, v160, v7 src0_sel:BYTE_0 src1_sel:DWORD
    v_mul_f32_dpp v165, v163, v164 row_newbcast:1 row_mask:0xf bank_mask:0xf
    v_permlane16_swap_b32 v152, v153
    v_add_f32 v152, v152, v153
    v_fma_f32 v152, -v165, v56, v152
    v_cvt_pk_bf16_f32 v156, v152, v152
    s_cbranch_vccnz Lr_175
Ld_176:
    ds_write_b16 v25, v156
    s_waitcnt lgkmcnt(0)
    s_barrier
    s_xor_b32 s48, s30, 5
    s_or_b32 s48, s48, s2
    s_cbranch_scc1 Lz_177
    s_mov_b64 exec, 1
    global_store_dword v7, v8, s[24:25] offset:0 sc1
    s_mov_b64 exec, -1
Lz_177:
    s_waitcnt lgkmcnt(0)
    s_barrier
    ds_read_b128 v[168:171], v46
    ds_read_b128 v[152:155], v28
    ds_read_b128 v[172:175], v46 offset:1024
    ds_read_b128 v[176:179], v46 offset:2048
    ds_read_b128 v[180:183], v46 offset:3072
    s_waitcnt lgkmcnt(4)
    v_mfma_f32_16x16x32_bf16 v[184:187], v[168:171], v[60:63], 0
    v_mfma_f32_16x16x32_bf16 v[200:203], v[168:171], v[76:79], 0
    s_waitcnt lgkmcnt(2)
    v_mfma_f32_16x16x32_bf16 v[188:191], v[172:175], v[64:67], 0
    v_max3_f32 v160, v152, v153, v154
    v_max_f32 v160, v160, v155
    v_mfma_f32_16x16x32_bf16 v[204:207], v[172:175], v[80:83], 0
    v_sub_f32 v152, v152, v160
    v_sub_f32 v153, v153, v160
    s_waitcnt lgkmcnt(1)
    v_mfma_f32_16x16x32_bf16 v[192:195], v[176:179], v[68:71], 0
    v_sub_f32 v154, v154, v160
    v_sub_f32 v155, v155, v160
    v_mfma_f32_16x16x32_bf16 v[208:211], v[176:179], v[84:87], 0
    v_exp_f32 v152, v152
    s_waitcnt lgkmcnt(0)
    v_mfma_f32_16x16x32_bf16 v[196:199], v[180:183], v[72:75], 0
    v_exp_f32 v153, v153
    v_mfma_f32_16x16x32_bf16 v[212:215], v[180:183], v[88:91], 0
    v_exp_f32 v154, v154
    v_exp_f32 v155, v155
    v_mul_f32 v164, v152, v184
    v_mul_f32 v165, v152, v200
    v_fmac_f32 v164, v153, v188
    v_fmac_f32 v165, v153, v204
    v_fmac_f32 v164, v154, v192
    v_fmac_f32 v165, v154, v208
    v_fmac_f32 v164, v155, v196
    v_fmac_f32 v165, v155, v212
    s_cmp_eq_u32 s37, 0
    v_cvt_pk_bf16_f32 v164, v164, v165
    v_min_u32 v164, -2, v164
    s_cbranch_scc1 Ls_179
    global_store_dword v47, v164, s[24:25]
Ls_180:
    s_barrier
Lj_178:
    s_mov_b32 s46, 0
    global_load_dword v160, v22, s[24:25] sc1
    global_load_dword v165, v22, s[24:25] offset:256 sc1
    global_load_dwordx4 v[152:155], v21, s[24:25] sc1
    global_load_dwordx4 v[156:159], v21, s[24:25] offset:1024 sc1
Lp_181:
    s_waitcnt vmcnt(2)
    v_max_f32_dpp v161, v160, v160 row_ror:1 row_mask:0xf bank_mask:0xf
    v_max_u32 v166, v160, v165
    s_nop 0
    v_max_f32_dpp v161, v161, v161 row_ror:2 row_mask:0xf bank_mask:0xf
    s_waitcnt vmcnt(1)
    v_mfma_f32_16x16x32_bf16 v[168:171], v[152:155], v[136:139], 0
    v_max_f32_dpp v161, v161, v161 row_ror:4 row_mask:0xf bank_mask:0xf
    v_sub_f32 v164, v160, v161
    v_mfma_f32_16x16x32_bf16 v[172:175], v[152:155], v[144:147], 0
    v_exp_f32 v164, v164
    s_waitcnt vmcnt(0)
    v_mfma_f32_16x16x32_bf16 v[168:171], v[156:159], v[140:143], v[168:171]
    v_mul_f32 v161, v164, v165
    v_max3_u32 v162, v152, v153, v154
    v_mfma_f32_16x16x32_bf16 v[172:175], v[156:159], v[148:151], v[172:175]
    v_add_f32_dpp v161, v161, v161 row_ror:1 row_mask:0xf bank_mask:0xf
    v_max3_u32 v163, v155, v156, v157
    v_max3_u32 v162, v162, v158, v159
    v_add_f32_dpp v161, v161, v161 row_ror:2 row_mask:0xf bank_mask:0xf
    v_max3_u32 v162, v162, v163, v166
    v_cmp_eq_u32 vcc, -1, v162
    v_add_f32_dpp v161, v161, v161 row_ror:4 row_mask:0xf bank_mask:0xf
    v_mul_f32_dpp v162, v164, v168 row_newbcast:0 row_mask:0xf bank_mask:0xf
    v_rcp_f32 v161, v161
    s_cbranch_vccnz Lr_182
Ld_183:
    s_mov_b64 exec, s[22:23]
    s_cbranch_execz Lh_184
    global_store_dword v43, v8, s[72:73] sc1
Lh_184:
    s_mov_b64 exec, -1
    v_fmac_f32_dpp v162, v164, v169 row_newbcast:1 row_mask:0xf bank_mask:0xf
    v_fmac_f32_dpp v162, v164, v170 row_newbcast:2 row_mask:0xf bank_mask:0xf
    v_fmac_f32_dpp v162, v164, v171 row_newbcast:3 row_mask:0xf bank_mask:0xf
    v_mul_f32_dpp v163, v164, v172 row_newbcast:0 row_mask:0xf bank_mask:0xf
    v_mul_f32 v162, v162, v161
    v_fmac_f32_dpp v163, v164, v173 row_newbcast:1 row_mask:0xf bank_mask:0xf
    ds_write_b32 v26, v162
    v_fmac_f32_dpp v163, v164, v174 row_newbcast:2 row_mask:0xf bank_mask:0xf
    v_fmac_f32_dpp v163, v164, v175 row_newbcast:3 row_mask:0xf bank_mask:0xf
    v_mul_f32 v163, v163, v161
    ds_write_b32 v26, v163 offset:2560
    s_waitcnt lgkmcnt(0)
    s_barrier
    s_barrier
Lj_185:
    s_mov_b32 s46, 0
    global_load_dwordx4 v[152:155], v12, s[72:73] sc1
    s_waitcnt vmcnt(0)
Lp_186:
    v_lshlrev_b32 v156, 16, v152
    v_and_b32 v157, 0xffff0000, v152
    v_lshlrev_b32 v160, 16, v154
    v_and_b32 v161, 0xffff0000, v154
    v_lshlrev_b32 v158, 16, v153
    v_and_b32 v159, 0xffff0000, v153
    v_lshlrev_b32 v162, 16, v155
    v_and_b32 v163, 0xffff0000, v155
    v_permlane32_swap_b32 v156, v160
    v_permlane32_swap_b32 v157, v161
    v_permlane32_swap_b32 v158, v162
    v_permlane32_swap_b32 v159, v163
    v_pk_add_f32 v[156:157], v[156:157], v[160:161]
    v_pk_add_f32 v[158:159], v[158:159], v[162:163]
    v_max3_u32 v152, v152, v153, v154
    s_nop 0
    v_permlane16_swap_b32 v156, v158
    v_permlane16_swap_b32 v157, v159
    v_pk_add_f32 v[156:157], v[156:157], v[158:159]
    v_max_u32 v152, v152, v155
    v_cmp_eq_u32 vcc, -1, v152
    v_add_f32_dpp v158, v156, v156 row_ror:8 row_mask:0xf bank_mask:0xf
    v_add_f32_dpp v159, v157, v157 row_ror:8 row_mask:0xf bank_mask:0xf
    v_pk_add_f32 v[158:159], v[158:159], v[54:55]
    v_cvt_pk_bf16_f32 v166, v158, v159
    s_cbranch_vccnz Lr_187
Ld_188:
    ds_write_b32 v23, v166
    v_lshlrev_b32 v54, 16, v166
    v_and_b32 v55, 0xffff0000, v166
    s_lshr_b32 s48, s30, 1
    s_sub_u32 s48, s48, 2
    s_or_b32 s48, s48, s92
    s_cmp_eq_u32 s48, 0
    s_cbranch_scc0 Lk_190
    s_waitcnt lgkmcnt(0)
    s_barrier
    ds_read_b128 v[168:171], v24 offset:0
    ds_read_b128 v[172:175], v24 offset:64
    ds_read_b128 v[176:179], v24 offset:128
    ds_read_b128 v[180:183], v24 offset:192
    s_waitcnt lgkmcnt(3)
    v_mfma_f32_16x16x32_bf16 v[184:187], v[168:171], v[92:95], 0
    s_waitcnt lgkmcnt(2)
    v_mfma_f32_16x16x32_bf16 v[184:187], v[172:175], v[96:99], v[184:187]
    s_waitcnt lgkmcnt(1)
    v_mfma_f32_16x16x32_bf16 v[184:187], v[176:179], v[100:103], v[184:187]
    s_waitcnt lgkmcnt(0)
    v_mfma_f32_16x16x32_bf16 v[184:187], v[180:183], v[104:107], v[184:187]
    s_cmp_eq_u32 s37, 0
    s_nop 6
    v_and_or_b32 v184, v184, s36, v6
    s_cbranch_scc1 Ls_191
    global_store_dword v34, v184, s[24:25]
Ls_192:
    s_barrier
    s_mov_b64 exec, -1
    s_branch Lj_189
L_pad19:
    s_setpc_b64 s[94:95]
Lk_190:
    s_waitcnt lgkmcnt(0)
    s_barrier
    s_barrier
Lj_189:
    s_cmp_ge_u32 s30, 7
    s_cbranch_scc1 Le_194
    s_mov_b32 s46, 0
    global_load_dword v162, v20, s[24:25] sc1
    global_load_dword v152, v17, s[24:25] sc1
    global_load_dword v153, v17, s[24:25] offset:256 sc1
    v_mov_b32 v164, 0x3b000000
    s_waitcnt vmcnt(0)
Lp_195:
    v_xor_b32 v162, v6, v162
    v_xor_b32 v152, v6, v152
    v_xor_b32 v153, v6, v153
    v_add_f32_dpp v163, v162, v162 row_ror:4 row_mask:0xf bank_mask:0xf
    v_add_f32 v156, v152, v153
    v_add_f32 v157, v152, v153
    v_add_f32_dpp v163, v163, v163 row_ror:8 row_mask:0xf bank_mask:0xf
    v_or3_b32 v160, v152, v153, v162
    v_permlane32_swap_b32 v156, v157
    v_mul_f32_dpp v165, v163, v164 row_newbcast:1 row_mask:0xf bank_mask:0xf
    v_mul_f32_dpp v164, v163, v164 row_newbcast:0 row_mask:0xf bank_mask:0xf
    v_cmp_ne_u32_sdwa vcc, v160, v7 src0_sel:BYTE_0 src1_sel:DWORD
    v_fma_f32 v164, -v165, v165, v164
    v_add_f32 v152, v156, v157
    v_max_f32 v164, 0, v164
    v_add_f32 v164, 0x3727c5ac, v164
    v_rsq_f32 v164, v164
    v_fma_f32 v152, -v165, v57, v152
    s_cbranch_vccnz Lr_196
Ld_197:
    s_mov_b64 exec, s[22:23]
    s_cbranch_execz Lh_198
    global_store_dword v43, v8, s[74:75] sc1
Lh_198:
    s_mov_b64 exec, -1
    v_mul_f32 v152, v152, v164
    v_mul_f32 v153, 0xbfb8aa3b, v152
    v_exp_f32 v153, v153
    s_nop 0
    v_add_f32 v153, 1.0, v153
    v_rcp_f32 v153, v153
    s_nop 0
    v_mul_f32 v152, v152, v153
    v_cvt_pk_bf16_f32 v152, v152, v152
    ds_write_b16 v27, v152
Le_193:
    s_xor_b32 s48, s26, s29
    s_xor_b32 s49, s30, 7
    s_or_b32 s48, s48, s49
    s_cmp_eq_u32 s48, 0
    s_cbranch_scc0 Lk_200
    s_mov_b32 s46, 0
    s_mov_b64 exec, 0xffff
    v_add_u32 v182, 4096, v13
    s_waitcnt lgkmcnt(0)
    s_barrier
    s_nop 15
    s_nop 15
    s_nop 7
    global_load_dword v9, v13, s[74:75] offset:0 sc1
    s_nop 15
    s_nop 15
    s_nop 2
    global_load_dword v18, v13, s[74:75] offset:2048 sc1
    s_waitcnt vmcnt(1)
    v_cmp_ne_u32 vcc, s31, v9
    s_cbranch_vccz Ld_202
    s_add_u32 s46, s46, 1
    global_load_dword v9, v182, s[74:75] offset:0 sc1
    s_waitcnt vmcnt(1)
    v_cmp_ne_u32 vcc, s31, v18
    s_cbranch_vccz Ld_202
    s_add_u32 s46, s46, 1
    global_load_dword v18, v182, s[74:75] offset:2048 sc1
Lp_201:
    s_waitcnt vmcnt(1)
    v_cmp_ne_u32 vcc, s31, v9
    s_cbranch_vccz Ld_202
    s_add_u32 s46, s46, 1
    global_load_dword v9, v182, s[74:75] offset:2048 sc1
    s_waitcnt vmcnt(1)
    v_cmp_ne_u32 vcc, s31, v18
    s_cbranch_vccz Ld_202
    s_add_u32 s46, s46, 1
    global_load_dword v18, v182, s[74:75] offset:2048 sc1
    s_cmp_lt_u32 s46, 0x8000
    s_cbranch_scc1 Lp_201
Ld_202:
    s_cmp_lg_u32 s26, s29
    s_cbranch_scc1 L_fin1
    s_barrier
    s_mov_b64 exec, -1
    s_branch Lj_199
L_pad21:
    s_setpc_b64 s[94:95]
Lk_200:
    s_waitcnt lgkmcnt(0)
    s_barrier
    s_cmp_lg_u32 s26, s29
    s_cbranch_scc1 L_fin1
    s_barrier
Lj_199:
    s_cmp_lg_u32 s30, s29
    s_cbranch_scc1 L_fin1
    s_mov_b32 s46, 0
    global_load_dwordx4 v[152:155], v12, s[74:75] sc1
    s_waitcnt vmcnt(0)
Lp_203:
    v_lshlrev_b32 v156, 16, v152
    v_and_b32 v157, 0xffff0000, v152
    v_lshlrev_b32 v160, 16, v154
    v_and_b32 v161, 0xffff0000, v154
    v_lshlrev_b32 v158, 16, v153
    v_and_b32 v159, 0xffff0000, v153
    v_lshlrev_b32 v162, 16, v155
    v_and_b32 v163, 0xffff0000, v155
    v_permlane32_swap_b32 v156, v160
    v_permlane32_swap_b32 v157, v161
    v_permlane32_swap_b32 v158, v162
    v_permlane32_swap_b32 v159, v163
    v_pk_add_f32 v[156:157], v[156:157], v[160:161]
    v_pk_add_f32 v[158:159], v[158:159], v[162:163]
    v_max3_u32 v152, v152, v153, v154
    s_nop 0
    v_permlane16_swap_b32 v156, v158
    v_permlane16_swap_b32 v157, v159
    v_pk_add_f32 v[156:157], v[156:157], v[158:159]
    v_max_u32 v152, v152, v155
    v_cmp_eq_u32 vcc, -1, v152
    v_add_f32_dpp v158, v156, v156 row_ror:8 row_mask:0xf bank_mask:0xf
    v_add_f32_dpp v159, v157, v157 row_ror:8 row_mask:0xf bank_mask:0xf
    v_pk_add_f32 v[158:159], v[158:159], v[54:55]
    v_cvt_pk_bf16_f32 v166, v158, v159
    s_cbranch_vccnz Lr_204
Ld_205:
    s_mov_b32 s42, 0x00ff00ff
    s_mov_b32 s43, 0x00ff00ff
    s_mov_b64 exec, s[42:43]
    global_store_dword v59, v166, s[20:21]
L_fin1:
    s_endpgm
Lr_18:
    s_add_u32 s46, s46, 1
    s_cmp_gt_u32 s46, 0x8000
    s_cbranch_scc1 Ld_19
    s_cmp_lt_u32 s46, 8
    s_cbranch_scc1 Lt_20
    s_cmp_lg_u32 s89, 0
    s_cbranch_scc1 Lt_21
    s_mov_b32 s89, 1
    v_add_u32 v142, 0x8000, v35
    global_store_dword v35, v140, s[40:41] sc1
    s_mov_b64 exec, 0xffff
    global_store_dword v142, v141, s[40:41] sc1
    s_mov_b64 exec, -1
    s_cmp_lg_u32 s30, 3
    s_cbranch_scc1 Lt_21
    s_mov_b64 exec, s[14:15]
    global_store_dwordx4 v45, v[144:147], s[40:41] sc1
    s_mov_b64 exec, -1
Lt_21:
    s_bitcmp1_b32 s46, 0
    s_cselect_b64 s[38:39], s[24:25], s[40:41]
Lt_20:
    s_sleep 1
    v_mov_b32 v162, v6
    s_mov_b64 exec, 0xffffffff
    global_load_dword v162, v198, s[38:39] sc1
    s_mov_b64 exec, -1
    global_load_dwordx4 v[152:155], v14, s[38:39] sc1
    global_load_dwordx4 v[156:159], v15, s[38:39] sc1
    global_load_dwordx4 v[168:171], v196, s[38:39] sc1
    global_load_dwordx4 v[172:175], v197, s[38:39] sc1
    v_mov_b32 v164, 0x3b000000
    s_waitcnt vmcnt(0)
    s_branch Lp_17
Lq_24:
    s_cmp_lg_u32 s89, 0
    s_cbranch_scc1 Lt_26
    s_mov_b32 s89, 1
    v_add_u32 v142, 0x8000, v35
    global_store_dword v35, v140, s[40:41] sc1
    s_mov_b64 exec, 0xffff
    global_store_dword v142, v141, s[40:41] sc1
    s_mov_b64 exec, -1
    s_cmp_lg_u32 s30, 3
    s_cbranch_scc1 Lt_26
    s_mov_b64 exec, s[14:15]
    global_store_dwordx4 v45, v[144:147], s[40:41] sc1
    s_mov_b64 exec, -1
Lt_26:
    s_branch Lq_25
Lt_27:
    s_cmp_lg_u32 s89, 0
    s_cbranch_scc1 Lt_30
    s_mov_b32 s89, 1
    v_add_u32 v142, 0x8000, v35
    global_store_dword v35, v140, s[40:41] sc1
    s_mov_b64 exec, 0xffff
    global_store_dword v142, v141, s[40:41] sc1
    s_mov_b64 exec, -1
    s_cmp_lg_u32 s30, 3
    s_cbranch_scc1 Lt_30
    s_mov_b64 exec, s[14:15]
    global_store_dwordx4 v45, v[144:147], s[40:41] sc1
    s_mov_b64 exec, -1
Lt_30:
    s_branch Lt_28
Ls_33:
    global_store_dword v47, v164, s[24:25] sc1
    s_branch Ls_34
Ls_37:
    global_store_dword v37, v160, s[24:25] sc1
    global_store_dword v37, v161, s[24:25] offset:256 sc1
    s_branch Ls_38
Ls_39:
    global_store_dword v49, v9, s[24:25] sc1
    s_branch Ls_40
L_pad0:
    s_branch L_pad4
Lm_35:
    s_cmp_lg_u32 s30, 2
    s_cbranch_scc1 Lm_36
    s_add_u32 s49, s3, 1
    v_mov_b32 v9, s49
    s_lshl_b32 s48, s55, 4
    s_lshl_b32 s42, 0xffff, s48
    s_mov_b32 s43, 0
    s_mov_b64 exec, 1
    s_cmp_eq_u32 s37, 0
    s_cbranch_scc1 Ls_39
    global_store_dword v49, v9, s[24:25]
Ls_40:
    s_mov_b64 exec, s[42:43]
    s_nop 15
    s_nop 3
    s_mov_b32 s46, 0
    global_load_dword v9, v50, s[24:25] sc1
    s_nop 13
    global_load_dword v18, v50, s[24:25] sc1
    s_nop 13
    global_load_dword v51, v50, s[24:25] sc1
    s_nop 13
    global_load_dword v52, v50, s[24:25] sc1
Lp_41:
    s_waitcnt vmcnt(3)
    v_subrev_u32 v9, s49, v9
    v_cmp_le_u32 vcc, 8, v9
    s_cbranch_vccz Ld_42
    global_load_dword v9, v50, s[24:25] sc1
    s_add_u32 s46, s46, 1
    s_waitcnt vmcnt(3)
    v_subrev_u32 v18, s49, v18
    v_cmp_le_u32 vcc, 8, v18
    s_cbranch_vccz Ld_42
    global_load_dword v18, v50, s[24:25] sc1
    s_add_u32 s46, s46, 1
    s_waitcnt vmcnt(3)
    v_subrev_u32 v51, s49, v51
    v_cmp_le_u32 vcc, 8, v51
    s_cbranch_vccz Ld_42
    global_load_dword v51, v50, s[24:25] sc1
    s_add_u32 s46, s46, 1
    s_waitcnt vmcnt(3)
    v_subrev_u32 v52, s49, v52
    v_cmp_le_u32 vcc, 8, v52
    s_cbranch_vccz Ld_42
    global_load_dword v52, v50, s[24:25] sc1
    s_add_u32 s46, s46, 1
    s_cmp_lt_u32 s46, 0x10000
    s_cbranch_scc1 Lp_41
Ld_42:
    s_mov_b64 exec, -1
    s_branch Lm_36
Lr_44:
    s_add_u32 s46, s46, 1
    s_cmp_gt_u32 s46, 0x8000
    s_cbranch_scc1 Ld_45
    global_load_dword v160, v22, s[24:25] sc1
    global_load_dword v165, v22, s[24:25] offset:256 sc1
    global_load_dwordx4 v[152:155], v21, s[24:25] sc1
    global_load_dwordx4 v[156:159], v21, s[24:25] offset:1024 sc1
    s_waitcnt vmcnt(0)
    s_branch Lp_43
Lr_61:
    s_add_u32 s46, s46, 1
    s_cmp_gt_u32 s46, 0x8000
    s_cbranch_scc1 Ld_62
    s_sleep 2
    global_load_dwordx4 v[152:155], v12, s[68:69] sc1
    s_waitcnt vmcnt(0)
    s_branch Lp_60
Ls_65:
    global_store_dwordx4 v36, v[188:191], s[24:25] sc1
    s_branch Ls_66
Ls_68:
    global_store_dword v49, v9, s[24:25] sc1
    s_branch Ls_69
Lr_75:
    s_add_u32 s46, s46, 1
    s_cmp_gt_u32 s46, 0x8000
    s_cbranch_scc1 Ld_76
    global_load_dword v162, v20, s[24:25] sc1
    global_load_dword v152, v17, s[24:25] sc1
    global_load_dword v153, v17, s[24:25] offset:256 sc1
    global_load_dword v154, v19, s[24:25] sc1
    global_load_dword v155, v19, s[24:25] offset:256 sc1
    v_mov_b32 v164, 0x3b000000
    s_waitcnt vmcnt(0)
    s_branch Lp_74
Lr_82:
    s_add_u32 s46, s46, 1
    s_cmp_gt_u32 s46, 0x8000
    s_cbranch_scc1 Ld_83
    s_sleep 2
    global_load_dwordx4 v[152:155], v12, s[70:71] sc1
    s_waitcnt vmcnt(0)
    s_branch Lp_81
Ls_85:
    global_store_dword v35, v184, s[38:39] sc1
    s_branch Ls_86
Lr_88:
    s_add_u32 s46, s46, 1
    s_cmp_gt_u32 s46, 0x8000
    s_cbranch_scc1 Ld_89
    global_load_dword v162, v16, s[38:39] sc1
    global_load_dwordx4 v[152:155], v14, s[38:39] sc1
    v_mov_b32 v164, 0x3b000000
    s_waitcnt vmcnt(0)
    s_branch Lp_87
Ls_92:
    global_store_dword v37, v160, s[24:25] sc1
    global_store_dword v37, v161, s[24:25] offset:256 sc1
    s_branch Ls_93
Ls_95:
    global_store_dword v49, v9, s[24:25] sc1
    s_branch Ls_96
Lr_100:
    s_add_u32 s46, s46, 1
    s_cmp_gt_u32 s46, 0x8000
    s_cbranch_scc1 Ld_101
    global_load_dword v160, v22, s[24:25] sc1
    global_load_dword v165, v22, s[24:25] offset:256 sc1
    global_load_dwordx4 v[152:155], v21, s[24:25] sc1
    global_load_dwordx4 v[156:159], v21, s[24:25] offset:1024 sc1
    s_waitcnt vmcnt(0)
    s_branch Lp_99
Lr_108:
    s_add_u32 s46, s46, 1
    s_cmp_gt_u32 s46, 0x8000
    s_cbranch_scc1 Ld_109
    s_sleep 2
    global_load_dwordx4 v[152:155], v12, s[72:73] sc1
    s_waitcnt vmcnt(0)
    s_branch Lp_107
Ls_112:
    global_store_dwordx4 v36, v[188:191], s[24:25] sc1
    s_branch Ls_113
Ls_115:
    global_store_dword v49, v9, s[24:25] sc1
    s_branch Ls_116
Lr_122:
    s_add_u32 s46, s46, 1
    s_cmp_gt_u32 s46, 0x8000
    s_cbranch_scc1 Ld_123
    global_load_dword v162, v20, s[24:25] sc1
    global_load_dword v152, v17, s[24:25] sc1
    global_load_dword v153, v17, s[24:25] offset:256 sc1
    v_mov_b32 v164, 0x3b000000
    s_waitcnt vmcnt(0)
    s_branch Lp_121
Lr_126:
    s_add_u32 s46, s46, 1
    s_cmp_gt_u32 s46, 0x8000
    s_cbranch_scc1 Ld_127
    s_sleep 2
    global_load_dwordx4 v[152:155], v12, s[74:75] sc1
    s_waitcnt vmcnt(0)
    s_branch Lp_125
Lr_129:
    s_add_u32 s46, s46, 1
    s_cmp_gt_u32 s46, 0x8000
    s_cbranch_scc1 Ld_130
    global_load_dword v160, v22, s[24:25] sc1
    global_load_dword v165, v22, s[24:25] offset:256 sc1
    global_load_dwordx4 v[152:155], v21, s[24:25] sc1
    global_load_dwordx4 v[156:159], v21, s[24:25] offset:1024 sc1
    s_waitcnt vmcnt(0)
    s_branch Lp_128
Lr_139:
    s_add_u32 s46, s46, 1
    s_cmp_gt_u32 s46, 0x8000
    s_cbranch_scc1 Ld_140
    s_sleep 2
    global_load_dwordx4 v[152:155], v12, s[68:69] sc1
    s_waitcnt vmcnt(0)
    s_branch Lp_138
Ls_143:
    global_store_dword v34, v184, s[24:25] sc1
    s_mov_b64 exec, 0xffff
    global_store_dword v188, v185, s[24:25] sc1
    s_mov_b64 exec, -1
    s_branch Ls_144
L_pad14:
    s_branch L_pad18
Le_146:
    s_branch Le_145
Lr_148:
    s_add_u32 s46, s46, 1
    s_cmp_gt_u32 s46, 0x8000
    s_cbranch_scc1 Ld_149
    global_load_dword v162, v20, s[24:25] sc1
    global_load_dword v152, v17, s[24:25] sc1
    global_load_dword v153, v17, s[24:25] offset:256 sc1
    global_load_dword v154, v19, s[24:25] sc1
    global_load_dword v155, v19, s[24:25] offset:256 sc1
    v_mov_b32 v164, 0x3b000000
    s_waitcnt vmcnt(0)
    s_branch Lp_147
Lr_163:
    s_add_u32 s46, s46, 1
    s_cmp_gt_u32 s46, 0x8000
    s_cbranch_scc1 Ld_164
    s_sleep 2
    global_load_dwordx4 v[152:155], v12, s[70:71] sc1
    s_waitcnt vmcnt(0)
    s_branch Lp_162
Ls_167:
    global_store_dwordx4 v45, v[188:191], s[38:39] sc1
    s_branch Ls_168
Ls_170:
    global_store_dword v49, v9, s[24:25] sc1
    s_branch Ls_171
Lr_175:
    s_add_u32 s46, s46, 1
    s_cmp_gt_u32 s46, 0x8000
    s_cbranch_scc1 Ld_176
    global_load_dword v162, v16, s[38:39] sc1
    global_load_dwordx4 v[152:155], v14, s[38:39] sc1
    v_mov_b32 v164, 0x3b000000
    s_waitcnt vmcnt(0)
    s_branch Lp_174
Ls_179:
    global_store_dword v47, v164, s[24:25] sc1
    s_branch Ls_180
Lr_182:
    s_add_u32 s46, s46, 1
    s_cmp_gt_u32 s46, 0x8000
    s_cbranch_scc1 Ld_183
    global_load_dword v160, v22, s[24:25] sc1
    global_load_dword v165, v22, s[24:25] offset:256 sc1
    global_load_dwordx4 v[152:155], v21, s[24:25] sc1
    global_load_dwordx4 v[156:159], v21, s[24:25] offset:1024 sc1
    s_waitcnt vmcnt(0)
    s_branch Lp_181
Lr_187:
    s_add_u32 s46, s46, 1
    s_cmp_gt_u32 s46, 0x8000
    s_cbranch_scc1 Ld_188
    s_sleep 2
    global_load_dwordx4 v[152:155], v12, s[72:73] sc1
    s_waitcnt vmcnt(0)
    s_branch Lp_186
Ls_191:
    global_store_dword v34, v184, s[24:25] sc1
    s_branch Ls_192
L_pad20:
    s_setpc_b64 s[94:95]
Le_194:
    s_branch Le_193
Lr_196:
    s_add_u32 s46, s46, 1
    s_cmp_gt_u32 s46, 0x8000
    s_cbranch_scc1 Ld_197
    global_load_dword v162, v20, s[24:25] sc1
    global_load_dword v152, v17, s[24:25] sc1
    global_load_dword v153, v17, s[24:25] offset:256 sc1
    v_mov_b32 v164, 0x3b000000
    s_waitcnt vmcnt(0)
    s_branch Lp_195
Lr_204:
    s_add_u32 s46, s46, 1
    s_cmp_gt_u32 s46, 0x8000
    s_cbranch_scc1 Ld_205
    s_sleep 2
    global_load_dwordx4 v[152:155], v12, s[74:75] sc1
    s_waitcnt vmcnt(0)
    s_branch Lp_203
L_end:
s_endpgm
L_pad:
.fill (33024 - (L_pad - interleave_layers__sliding_block_cached__dense_activation_silu__decode_kernel)) / 4, 4, 0xbf810000
.section .rodata,"a"
.p2align 6
.amdhsa_kernel interleave_layers__sliding_block_cached__dense_activation_silu__decode_kernel
  .amdhsa_next_free_vgpr 216
  .amdhsa_next_free_sgpr 102
  .amdhsa_accum_offset 216
  .amdhsa_group_segment_fixed_size 0
  .amdhsa_kernarg_size 88
  .amdhsa_user_sgpr_count 2
  .amdhsa_user_sgpr_kernarg_segment_ptr 1
  .amdhsa_system_sgpr_workgroup_id_x 1
.end_amdhsa_kernel
```
